```python
import torch

def _softmax(x, axis=-1):
    return torch.softmax(x, dim=axis)
def _gelu(x):
    return torch.nn.functional.gelu(x, approximate="tanh")
def _silu(x):
    return torch.nn.functional.silu(x)
def _sigmoid(x):
    return torch.sigmoid(x)
def _layernorm(x, axis=-1, eps=1e-5):
    m = x.mean(dim=axis, keepdim=True)
    v = x.var(dim=axis, keepdim=True, unbiased=False)
    return (x - m) / torch.sqrt(v + eps)
def _scatter_add(tgt, idx, src, axis=0):
    return tgt.clone().index_add_(axis, idx, src)
def _segment_sum(src, seg, n):
    out = torch.zeros((n,) + src.shape[1:], dtype=src.dtype)
    return out.index_add_(0, seg, src)
def _pad(x, pw):
    flat = tuple(v for pair in reversed(pw) for v in pair)
    return torch.nn.functional.pad(x, flat)

kernel_name = 'standalone__gqa_block_cached__decode'

def setup_inputs():

    _w = (lambda a: (lambda t: t.to(torch.bfloat16) if t.is_floating_point() else t)(torch.as_tensor(a)))
    B, Sq, D = 2, 1, 1024
    Hq, Hkv, Sk, Dh = 32, 4, 32768, 128
    assert Hq % Hkv == 0, (Hq, Hkv)
    return {
        "x": _w((lambda *s: torch.randn(*s, dtype=torch.bfloat16) * 0.8)(B, Sq, D)),
        "k_cache": _w((lambda *s: torch.randn(*s, dtype=torch.bfloat16) * 0.8)(B, Hkv, Sk, Dh)),
        "v_cache": _w((lambda *s: torch.randn(*s, dtype=torch.bfloat16) * 0.05)(B, Hkv, Sk, Dh)),
        "wq": _w((lambda *s: torch.randn(*s, dtype=torch.bfloat16) * 0.8)(D, Hq * Dh) * (D ** -0.5)),
        "wo": _w((lambda *s: torch.randn(*s, dtype=torch.bfloat16) * 0.05)(Hq * Dh, D) * ((Hq * Dh) ** -0.5)),
    }

def reference(x, k_cache, v_cache, wq, wo):
    B, Sq, D = x.shape
    Hq, Dh = 32, 128
    Hkv = k_cache.shape[1]
    rep = Hq // Hkv
    q = (lambda x, *d: x.permute(*d))((x @ wq).reshape(B, Sq, Hq, Dh), 0, 2, 1, 3)
    k = (lambda x, n, axis: torch.repeat_interleave(x, n, dim=axis))(k_cache, rep, axis=1)
    v = (lambda x, n, axis: torch.repeat_interleave(x, n, dim=axis))(v_cache, rep, axis=1)
    scores = torch.einsum("bhqd,bhkd->bhqk", q, k) * (Dh ** -0.5)
    p = _softmax(scores, axis=-1)
    o = torch.einsum("bhqk,bhkd->bhqd", p, v)
    return (lambda x, *d: x.permute(*d))(o, 0, 2, 1, 3).reshape(B, Sq, Hq * Dh) @ wo
```

```asm
; @launch grid=(256,1,1) block=(320,1,1) lds=134656
.amdgcn_target "amdgcn-amd-amdhsa--gfx950"
.text
.globl standalone__gqa_block_cached__decode_kernel
.p2align 8
.type standalone__gqa_block_cached__decode_kernel,@function
standalone__gqa_block_cached__decode_kernel:
  s_cmp_ge_u32 s2, 256
  s_cbranch_scc1 L_done
  s_load_dwordx16 s[4:19], s[0:1], 0
  v_lshrrev_b32 v1, 6, v0
  v_and_b32 v0, 63, v0
  v_readfirstlane_b32 s3, v1
  v_and_b32 v1, 15, v0
  v_lshrrev_b32 v2, 4, v0
  s_mov_b32 s48, 0x05040100
  s_mov_b32 s49, 0x07060302
  s_mov_b32 s50, 0x3e0293ee
  s_and_b32 s56, s2, 3
  s_lshr_b32 s62, s2, 2
  s_and_b32 s55, s62, 1
  s_lshr_b32 s57, s2, 3
  s_lshr_b32 s58, s2, 5
  s_lshl_b32 s64, s56, 3
  s_add_u32 s58, s58, s64
  s_and_b32 s63, s62, 7
  s_bfe_u32 s59, s2, 0x20003
  s_mov_b32 s60, s55
  s_lshl_b32 s64, s56, 4
  s_add_u32 s64, s64, s55
  s_lshl_b32 s64, s64, 5
  s_add_u32 s64, s64, s57
  s_mul_i32 s66, s64, 640
  s_add_u32 s66, s66, 1048576
  s_lshl_b32 s64, s58, 2
  s_add_u32 s64, s64, s59
  s_mul_i32 s64, s64, 8320
  s_lshl_b32 s67, s60, 11
  s_add_u32 s67, s67, s64
  s_add_u32 s67, s67, 3145728
  s_waitcnt lgkmcnt(0)
  s_mov_b32 s32, s18
  s_and_b32 s33, s19, 0xffff
  s_mov_b32 s34, 8388608
  s_mov_b32 s35, 0x20000
  s_cmp_eq_u32 s3, 4
  s_cbranch_scc1 L_helper
  s_mov_b32 s20, s6
  s_and_b32 s21, s7, 0xffff
  s_mov_b32 s22, 67108864
  s_mov_b32 s23, 0x20000
  s_mov_b32 s24, s8
  s_and_b32 s25, s9, 0xffff
  s_mov_b32 s26, 67108864
  s_mov_b32 s27, 0x20000
  s_mov_b32 s28, s12
  s_and_b32 s29, s13, 0xffff
  s_mov_b32 s30, 8388608
  s_mov_b32 s31, 0x20000
  s_and_b32 s51, s2, 7
  s_lshl_b32 s51, s51, 23
  s_lshl_b32 s52, s57, 2
  s_add_u32 s52, s52, s3
  s_lshl_b32 s52, s52, 12
  s_add_u32 s51, s51, s52
  s_lshl_b32 s54, s3, 15
  v_add_u32 v3, 0, v2
  v_xor_b32 v3, v3, v1
  v_lshlrev_b32 v3, 4, v3
  v_lshl_add_u32 v4, v2, 8, v3
  v_add_u32 v3, 4, v2
  v_xor_b32 v3, v3, v1
  v_lshlrev_b32 v3, 4, v3
  v_lshl_add_u32 v5, v2, 8, v3
  v_add_u32 v3, 8, v2
  v_xor_b32 v3, v3, v1
  v_lshlrev_b32 v3, 4, v3
  v_lshl_add_u32 v6, v2, 8, v3
  v_add_u32 v3, 12, v2
  v_xor_b32 v3, v3, v1
  v_lshlrev_b32 v3, 4, v3
  v_lshl_add_u32 v7, v2, 8, v3
  v_add_u32 v3, 0, v2
  v_xor_b32 v3, v3, v1
  v_lshlrev_b32 v3, 4, v3
  v_lshl_add_u32 v3, v1, 8, v3
  v_add_u32 v8, s54, v3
  v_add_u32 v3, 4, v2
  v_xor_b32 v3, v3, v1
  v_lshlrev_b32 v3, 4, v3
  v_lshl_add_u32 v3, v1, 8, v3
  v_add_u32 v9, s54, v3
  v_add_u32 v3, 8, v2
  v_xor_b32 v3, v3, v1
  v_lshlrev_b32 v3, 4, v3
  v_lshl_add_u32 v3, v1, 8, v3
  v_add_u32 v10, s54, v3
  v_add_u32 v3, 12, v2
  v_xor_b32 v3, v3, v1
  v_lshlrev_b32 v3, 4, v3
  v_lshl_add_u32 v3, v1, 8, v3
  v_add_u32 v11, s54, v3
  v_lshlrev_b32 v3, 4, v1
  v_lshl_add_u32 v12, v2, 10, v3
  s_and_b32 s93, s2, 7
  s_mul_i32 s93, s93, 5
  s_barrier
  s_add_u32 s52, s93, 0
  s_and_b32 s52, s52, 15
  s_lshl_b32 s52, s52, 19
  s_add_u32 s52, s52, s51
  s_add_u32 m0, s54, 0
  s_nop 0
  buffer_load_dwordx4 v4, s[20:23], s52 offen offset:0 nt lds
  buffer_load_dwordx4 v5, s[20:23], s52 offen offset:1024 nt lds
  buffer_load_dwordx4 v6, s[20:23], s52 offen offset:2048 nt lds
  buffer_load_dwordx4 v7, s[20:23], s52 offen offset:3072 nt lds
  s_add_u32 s52, s93, 1
  s_and_b32 s52, s52, 15
  s_lshl_b32 s52, s52, 19
  s_add_u32 s52, s52, s51
  s_add_u32 m0, s54, 4096
  s_nop 0
  buffer_load_dwordx4 v4, s[20:23], s52 offen offset:0 nt lds
  buffer_load_dwordx4 v5, s[20:23], s52 offen offset:1024 nt lds
  s_waitcnt vmcnt(5)
  buffer_load_dwordx4 v6, s[20:23], s52 offen offset:2048 nt lds
  s_waitcnt vmcnt(5)
  buffer_load_dwordx4 v7, s[20:23], s52 offen offset:3072 nt lds
  s_add_u32 s52, s93, 2
  s_and_b32 s52, s52, 15
  s_lshl_b32 s52, s52, 19
  s_add_u32 s52, s52, s51
  s_add_u32 m0, s54, 8192
  s_nop 0
  s_waitcnt vmcnt(5)
  buffer_load_dwordx4 v4, s[20:23], s52 offen offset:0 nt lds
  s_waitcnt vmcnt(5)
  buffer_load_dwordx4 v5, s[20:23], s52 offen offset:1024 nt lds
  s_waitcnt vmcnt(5)
  buffer_load_dwordx4 v6, s[20:23], s52 offen offset:2048 nt lds
  s_waitcnt vmcnt(5)
  buffer_load_dwordx4 v7, s[20:23], s52 offen offset:3072 nt lds
  s_add_u32 s52, s93, 3
  s_and_b32 s52, s52, 15
  s_lshl_b32 s52, s52, 19
  s_add_u32 s52, s52, s51
  s_add_u32 m0, s54, 12288
  s_nop 0
  s_waitcnt vmcnt(5)
  buffer_load_dwordx4 v4, s[20:23], s52 offen offset:0 nt lds
  s_waitcnt vmcnt(5)
  buffer_load_dwordx4 v5, s[20:23], s52 offen offset:1024 nt lds
  s_waitcnt vmcnt(5)
  buffer_load_dwordx4 v6, s[20:23], s52 offen offset:2048 nt lds
  s_waitcnt vmcnt(5)
  buffer_load_dwordx4 v7, s[20:23], s52 offen offset:3072 nt lds
  s_add_u32 s53, s93, 0
  s_and_b32 s53, s53, 15
  s_lshl_b32 s53, s53, 19
  s_add_u32 s53, s53, s51
  s_waitcnt vmcnt(5)
  buffer_load_dwordx4 v[128:131], v12, s[24:27], s53 offen offset:0 nt
  s_waitcnt vmcnt(5)
  buffer_load_dwordx4 v[132:135], v12, s[24:27], s53 offen offset:256 nt
  s_waitcnt vmcnt(5)
  buffer_load_dwordx4 v[136:139], v12, s[24:27], s53 offen offset:512 nt
  s_waitcnt vmcnt(5)
  buffer_load_dwordx4 v[140:143], v12, s[24:27], s53 offen offset:768 nt
  s_add_u32 s53, s93, 1
  s_and_b32 s53, s53, 15
  s_lshl_b32 s53, s53, 19
  s_add_u32 s53, s53, s51
  s_waitcnt vmcnt(5)
  buffer_load_dwordx4 v[144:147], v12, s[24:27], s53 offen offset:0 nt
  s_waitcnt vmcnt(5)
  buffer_load_dwordx4 v[148:151], v12, s[24:27], s53 offen offset:256 nt
  s_waitcnt vmcnt(5)
  buffer_load_dwordx4 v[152:155], v12, s[24:27], s53 offen offset:512 nt
  s_waitcnt vmcnt(5)
  buffer_load_dwordx4 v[156:159], v12, s[24:27], s53 offen offset:768 nt
  s_add_u32 s53, s93, 2
  s_and_b32 s53, s53, 15
  s_lshl_b32 s53, s53, 19
  s_add_u32 s53, s53, s51
  s_waitcnt vmcnt(5)
  buffer_load_dwordx4 v[160:163], v12, s[24:27], s53 offen offset:0 nt
  s_waitcnt vmcnt(5)
  buffer_load_dwordx4 v[164:167], v12, s[24:27], s53 offen offset:256 nt
  s_waitcnt vmcnt(5)
  buffer_load_dwordx4 v[168:171], v12, s[24:27], s53 offen offset:512 nt
  s_waitcnt vmcnt(5)
  buffer_load_dwordx4 v[172:175], v12, s[24:27], s53 offen offset:768 nt
  s_add_u32 s53, s93, 3
  s_and_b32 s53, s53, 15
  s_lshl_b32 s53, s53, 19
  s_add_u32 s53, s53, s51
  s_waitcnt vmcnt(5)
  buffer_load_dwordx4 v[176:179], v12, s[24:27], s53 offen offset:0 nt
  s_waitcnt vmcnt(5)
  buffer_load_dwordx4 v[180:183], v12, s[24:27], s53 offen offset:256 nt
  s_waitcnt vmcnt(5)
  buffer_load_dwordx4 v[184:187], v12, s[24:27], s53 offen offset:512 nt
  s_waitcnt vmcnt(5)
  buffer_load_dwordx4 v[188:191], v12, s[24:27], s53 offen offset:768 nt
  s_add_u32 s52, s93, 4
  s_and_b32 s52, s52, 15
  s_lshl_b32 s52, s52, 19
  s_add_u32 s52, s52, s51
  s_add_u32 m0, s54, 16384
  s_nop 0
  s_waitcnt vmcnt(5)
  buffer_load_dwordx4 v4, s[20:23], s52 offen offset:0 nt lds
  s_waitcnt vmcnt(5)
  buffer_load_dwordx4 v5, s[20:23], s52 offen offset:1024 nt lds
  s_waitcnt vmcnt(5)
  buffer_load_dwordx4 v6, s[20:23], s52 offen offset:2048 nt lds
  s_waitcnt vmcnt(5)
  buffer_load_dwordx4 v7, s[20:23], s52 offen offset:3072 nt lds
  s_add_u32 s52, s93, 5
  s_and_b32 s52, s52, 15
  s_lshl_b32 s52, s52, 19
  s_add_u32 s52, s52, s51
  s_add_u32 m0, s54, 20480
  s_nop 0
  s_waitcnt vmcnt(5)
  buffer_load_dwordx4 v4, s[20:23], s52 offen offset:0 nt lds
  s_waitcnt vmcnt(5)
  buffer_load_dwordx4 v5, s[20:23], s52 offen offset:1024 nt lds
  s_waitcnt vmcnt(5)
  buffer_load_dwordx4 v6, s[20:23], s52 offen offset:2048 nt lds
  s_waitcnt vmcnt(5)
  buffer_load_dwordx4 v7, s[20:23], s52 offen offset:3072 nt lds
  s_add_u32 s52, s93, 6
  s_and_b32 s52, s52, 15
  s_lshl_b32 s52, s52, 19
  s_add_u32 s52, s52, s51
  s_add_u32 m0, s54, 24576
  s_nop 0
  s_waitcnt vmcnt(5)
  buffer_load_dwordx4 v4, s[20:23], s52 offen offset:0 nt lds
  s_waitcnt vmcnt(5)
  buffer_load_dwordx4 v5, s[20:23], s52 offen offset:1024 nt lds
  s_waitcnt vmcnt(5)
  buffer_load_dwordx4 v6, s[20:23], s52 offen offset:2048 nt lds
  s_waitcnt vmcnt(5)
  buffer_load_dwordx4 v7, s[20:23], s52 offen offset:3072 nt lds
  s_add_u32 s52, s93, 7
  s_and_b32 s52, s52, 15
  s_lshl_b32 s52, s52, 19
  s_add_u32 s52, s52, s51
  s_add_u32 m0, s54, 28672
  s_nop 0
  s_waitcnt vmcnt(5)
  buffer_load_dwordx4 v4, s[20:23], s52 offen offset:0 nt lds
  s_waitcnt vmcnt(5)
  buffer_load_dwordx4 v5, s[20:23], s52 offen offset:1024 nt lds
  s_waitcnt vmcnt(5)
  buffer_load_dwordx4 v6, s[20:23], s52 offen offset:2048 nt lds
  s_waitcnt vmcnt(5)
  buffer_load_dwordx4 v7, s[20:23], s52 offen offset:3072 nt lds
  s_add_u32 s53, s93, 4
  s_and_b32 s53, s53, 15
  s_lshl_b32 s53, s53, 19
  s_add_u32 s53, s53, s51
  s_waitcnt vmcnt(5)
  buffer_load_dwordx4 v[192:195], v12, s[24:27], s53 offen offset:0 nt
  s_waitcnt vmcnt(5)
  buffer_load_dwordx4 v[196:199], v12, s[24:27], s53 offen offset:256 nt
  s_waitcnt vmcnt(5)
  buffer_load_dwordx4 v[200:203], v12, s[24:27], s53 offen offset:512 nt
  s_waitcnt vmcnt(5)
  buffer_load_dwordx4 v[204:207], v12, s[24:27], s53 offen offset:768 nt
  s_add_u32 s53, s93, 5
  s_and_b32 s53, s53, 15
  s_lshl_b32 s53, s53, 19
  s_add_u32 s53, s53, s51
  s_waitcnt vmcnt(5)
  buffer_load_dwordx4 v[208:211], v12, s[24:27], s53 offen offset:0 nt
  s_waitcnt vmcnt(5)
  buffer_load_dwordx4 v[212:215], v12, s[24:27], s53 offen offset:256 nt
  s_waitcnt vmcnt(5)
  buffer_load_dwordx4 v[216:219], v12, s[24:27], s53 offen offset:512 nt
  s_waitcnt vmcnt(5)
  buffer_load_dwordx4 v[220:223], v12, s[24:27], s53 offen offset:768 nt
  s_add_u32 s53, s93, 6
  s_and_b32 s53, s53, 15
  s_lshl_b32 s53, s53, 19
  s_add_u32 s53, s53, s51
  s_waitcnt vmcnt(5)
  buffer_load_dwordx4 v[224:227], v12, s[24:27], s53 offen offset:0 nt
  s_waitcnt vmcnt(5)
  buffer_load_dwordx4 v[228:231], v12, s[24:27], s53 offen offset:256 nt
  s_waitcnt vmcnt(5)
  buffer_load_dwordx4 v[232:235], v12, s[24:27], s53 offen offset:512 nt
  s_waitcnt vmcnt(5)
  buffer_load_dwordx4 v[236:239], v12, s[24:27], s53 offen offset:768 nt
  s_add_u32 s53, s93, 7
  s_and_b32 s53, s53, 15
  s_lshl_b32 s53, s53, 19
  s_add_u32 s53, s53, s51
  s_waitcnt vmcnt(5)
  buffer_load_dwordx4 v[240:243], v12, s[24:27], s53 offen offset:0 nt
  s_waitcnt vmcnt(5)
  buffer_load_dwordx4 v[244:247], v12, s[24:27], s53 offen offset:256 nt
  s_waitcnt vmcnt(5)
  buffer_load_dwordx4 v[248:251], v12, s[24:27], s53 offen offset:512 nt
  s_waitcnt vmcnt(5)
  buffer_load_dwordx4 v[252:255], v12, s[24:27], s53 offen offset:768 nt
  v_and_b32 v3, 7, v1
  v_lshlrev_b32 v3, 8, v3
  v_lshl_add_u32 v3, v2, 4, v3
  v_add_u32 v3, 131072, v3
  s_barrier
  ds_read_b128 v[20:23], v3 offset:0
  ds_read_b128 v[24:27], v3 offset:64
  ds_read_b128 v[28:31], v3 offset:128
  ds_read_b128 v[32:35], v3 offset:192
  s_waitcnt lgkmcnt(0)
  ds_read_b128 v[84:87], v8 offset:0
  ds_read_b128 v[88:91], v9 offset:0
  ds_read_b128 v[92:95], v10 offset:0
  ds_read_b128 v[96:99], v11 offset:0
  ds_read_b128 v[100:103], v8 offset:4096
  ds_read_b128 v[104:107], v9 offset:4096
  ds_read_b128 v[108:111], v10 offset:4096
  ds_read_b128 v[112:115], v11 offset:4096
  s_waitcnt lgkmcnt(4)
  v_mfma_f32_16x16x32_bf16 v[36:39], v[84:87], v[20:23], 0
  v_mfma_f32_16x16x32_bf16 v[36:39], v[88:91], v[24:27], v[36:39]
  v_mfma_f32_16x16x32_bf16 v[36:39], v[92:95], v[28:31], v[36:39]
  v_mfma_f32_16x16x32_bf16 v[36:39], v[96:99], v[32:35], v[36:39]
  s_waitcnt lgkmcnt(0)
  v_mfma_f32_16x16x32_bf16 v[40:43], v[100:103], v[20:23], 0
  v_mfma_f32_16x16x32_bf16 v[40:43], v[104:107], v[24:27], v[40:43]
  v_mfma_f32_16x16x32_bf16 v[40:43], v[108:111], v[28:31], v[40:43]
  v_mfma_f32_16x16x32_bf16 v[40:43], v[112:115], v[32:35], v[40:43]
  ds_read_b128 v[84:87], v8 offset:8192
  ds_read_b128 v[88:91], v9 offset:8192
  ds_read_b128 v[92:95], v10 offset:8192
  ds_read_b128 v[96:99], v11 offset:8192
  ds_read_b128 v[100:103], v8 offset:12288
  ds_read_b128 v[104:107], v9 offset:12288
  ds_read_b128 v[108:111], v10 offset:12288
  ds_read_b128 v[112:115], v11 offset:12288
  s_waitcnt lgkmcnt(4)
  v_mfma_f32_16x16x32_bf16 v[44:47], v[84:87], v[20:23], 0
  v_mfma_f32_16x16x32_bf16 v[44:47], v[88:91], v[24:27], v[44:47]
  v_mfma_f32_16x16x32_bf16 v[44:47], v[92:95], v[28:31], v[44:47]
  v_mfma_f32_16x16x32_bf16 v[44:47], v[96:99], v[32:35], v[44:47]
  s_waitcnt lgkmcnt(0)
  v_mfma_f32_16x16x32_bf16 v[48:51], v[100:103], v[20:23], 0
  v_mfma_f32_16x16x32_bf16 v[48:51], v[104:107], v[24:27], v[48:51]
  v_mfma_f32_16x16x32_bf16 v[48:51], v[108:111], v[28:31], v[48:51]
  v_mfma_f32_16x16x32_bf16 v[48:51], v[112:115], v[32:35], v[48:51]
  s_add_u32 s52, s93, 8
  s_and_b32 s52, s52, 15
  s_lshl_b32 s52, s52, 19
  s_add_u32 s52, s52, s51
  s_add_u32 m0, s54, 0
  s_nop 0
  buffer_load_dwordx4 v4, s[20:23], s52 offen offset:0 nt lds
  buffer_load_dwordx4 v5, s[20:23], s52 offen offset:1024 nt lds
  buffer_load_dwordx4 v6, s[20:23], s52 offen offset:2048 nt lds
  buffer_load_dwordx4 v7, s[20:23], s52 offen offset:3072 nt lds
  s_add_u32 s52, s93, 9
  s_and_b32 s52, s52, 15
  s_lshl_b32 s52, s52, 19
  s_add_u32 s52, s52, s51
  s_add_u32 m0, s54, 4096
  s_nop 0
  buffer_load_dwordx4 v4, s[20:23], s52 offen offset:0 nt lds
  buffer_load_dwordx4 v5, s[20:23], s52 offen offset:1024 nt lds
  buffer_load_dwordx4 v6, s[20:23], s52 offen offset:2048 nt lds
  buffer_load_dwordx4 v7, s[20:23], s52 offen offset:3072 nt lds
  s_add_u32 s52, s93, 10
  s_and_b32 s52, s52, 15
  s_lshl_b32 s52, s52, 19
  s_add_u32 s52, s52, s51
  s_add_u32 m0, s54, 8192
  s_nop 0
  buffer_load_dwordx4 v4, s[20:23], s52 offen offset:0 nt lds
  buffer_load_dwordx4 v5, s[20:23], s52 offen offset:1024 nt lds
  buffer_load_dwordx4 v6, s[20:23], s52 offen offset:2048 nt lds
  buffer_load_dwordx4 v7, s[20:23], s52 offen offset:3072 nt lds
  s_add_u32 s52, s93, 11
  s_and_b32 s52, s52, 15
  s_lshl_b32 s52, s52, 19
  s_add_u32 s52, s52, s51
  s_add_u32 m0, s54, 12288
  s_nop 0
  buffer_load_dwordx4 v4, s[20:23], s52 offen offset:0 nt lds
  buffer_load_dwordx4 v5, s[20:23], s52 offen offset:1024 nt lds
  buffer_load_dwordx4 v6, s[20:23], s52 offen offset:2048 nt lds
  buffer_load_dwordx4 v7, s[20:23], s52 offen offset:3072 nt lds
  s_nop 1
  v_max3_f32 v17, v36, v37, v38
  v_max3_f32 v17, v17, v39, v40
  v_max3_f32 v17, v17, v41, v42
  v_max3_f32 v17, v17, v43, v44
  v_max3_f32 v17, v17, v45, v46
  v_max3_f32 v17, v17, v47, v48
  v_max3_f32 v17, v17, v49, v50
  v_max_f32 v17, v17, v51
  v_mov_b32 v18, v17
  s_nop 1
  v_permlane16_swap_b32 v17, v18
  s_nop 1
  v_max_f32 v17, v17, v18
  v_mov_b32 v18, v17
  s_nop 1
  v_permlane32_swap_b32 v17, v18
  s_nop 1
  v_max_f32 v17, v17, v18
  v_mov_b32 v14, v17
  v_mul_f32 v16, s50, v17
  v_fma_f32 v36, v36, s50, -v16
  v_fma_f32 v37, v37, s50, -v16
  v_fma_f32 v38, v38, s50, -v16
  v_fma_f32 v39, v39, s50, -v16
  v_fma_f32 v40, v40, s50, -v16
  v_fma_f32 v41, v41, s50, -v16
  v_fma_f32 v42, v42, s50, -v16
  v_fma_f32 v43, v43, s50, -v16
  v_fma_f32 v44, v44, s50, -v16
  v_fma_f32 v45, v45, s50, -v16
  v_fma_f32 v46, v46, s50, -v16
  v_fma_f32 v47, v47, s50, -v16
  v_fma_f32 v48, v48, s50, -v16
  v_fma_f32 v49, v49, s50, -v16
  v_fma_f32 v50, v50, s50, -v16
  v_fma_f32 v51, v51, s50, -v16
  v_exp_f32 v36, v36
  v_exp_f32 v37, v37
  v_exp_f32 v38, v38
  v_exp_f32 v39, v39
  v_exp_f32 v40, v40
  v_exp_f32 v41, v41
  v_exp_f32 v42, v42
  v_exp_f32 v43, v43
  v_exp_f32 v44, v44
  v_exp_f32 v45, v45
  v_exp_f32 v46, v46
  v_exp_f32 v47, v47
  v_exp_f32 v48, v48
  v_exp_f32 v49, v49
  v_exp_f32 v50, v50
  v_exp_f32 v51, v51
  s_nop 0
  v_mov_b32 v15, v36
  v_add_f32 v15, v15, v37
  v_add_f32 v15, v15, v38
  v_add_f32 v15, v15, v39
  v_add_f32 v15, v15, v40
  v_add_f32 v15, v15, v41
  v_add_f32 v15, v15, v42
  v_add_f32 v15, v15, v43
  v_add_f32 v15, v15, v44
  v_add_f32 v15, v15, v45
  v_add_f32 v15, v15, v46
  v_add_f32 v15, v15, v47
  v_add_f32 v15, v15, v48
  v_add_f32 v15, v15, v49
  v_add_f32 v15, v15, v50
  v_add_f32 v15, v15, v51
  v_cvt_pk_bf16_f32 v36, v36, v37
  v_cvt_pk_bf16_f32 v37, v38, v39
  v_cvt_pk_bf16_f32 v38, v40, v41
  v_cvt_pk_bf16_f32 v39, v42, v43
  v_cvt_pk_bf16_f32 v44, v44, v45
  v_cvt_pk_bf16_f32 v45, v46, v47
  v_cvt_pk_bf16_f32 v46, v48, v49
  v_cvt_pk_bf16_f32 v47, v50, v51
  v_perm_b32 v84, v132, v128, s48
  v_perm_b32 v88, v132, v128, s49
  v_perm_b32 v85, v140, v136, s48
  v_perm_b32 v89, v140, v136, s49
  v_perm_b32 v86, v148, v144, s48
  v_perm_b32 v90, v148, v144, s49
  v_perm_b32 v87, v156, v152, s48
  v_perm_b32 v91, v156, v152, s49
  v_perm_b32 v92, v133, v129, s48
  v_perm_b32 v96, v133, v129, s49
  v_perm_b32 v93, v141, v137, s48
  v_perm_b32 v97, v141, v137, s49
  v_perm_b32 v94, v149, v145, s48
  v_perm_b32 v98, v149, v145, s49
  v_perm_b32 v95, v157, v153, s48
  v_perm_b32 v99, v157, v153, s49
  v_perm_b32 v100, v134, v130, s48
  v_perm_b32 v104, v134, v130, s49
  v_perm_b32 v101, v142, v138, s48
  v_perm_b32 v105, v142, v138, s49
  v_perm_b32 v102, v150, v146, s48
  v_perm_b32 v106, v150, v146, s49
  v_perm_b32 v103, v158, v154, s48
  v_perm_b32 v107, v158, v154, s49
  v_perm_b32 v108, v135, v131, s48
  v_perm_b32 v112, v135, v131, s49
  v_perm_b32 v109, v143, v139, s48
  v_perm_b32 v113, v143, v139, s49
  v_perm_b32 v110, v151, v147, s48
  v_perm_b32 v114, v151, v147, s49
  v_perm_b32 v111, v159, v155, s48
  v_perm_b32 v115, v159, v155, s49
  s_add_u32 s53, s93, 8
  s_and_b32 s53, s53, 15
  s_lshl_b32 s53, s53, 19
  s_add_u32 s53, s53, s51
  buffer_load_dwordx4 v[128:131], v12, s[24:27], s53 offen offset:0 nt
  buffer_load_dwordx4 v[132:135], v12, s[24:27], s53 offen offset:256 nt
  buffer_load_dwordx4 v[136:139], v12, s[24:27], s53 offen offset:512 nt
  buffer_load_dwordx4 v[140:143], v12, s[24:27], s53 offen offset:768 nt
  s_add_u32 s53, s93, 9
  s_and_b32 s53, s53, 15
  s_lshl_b32 s53, s53, 19
  s_add_u32 s53, s53, s51
  buffer_load_dwordx4 v[144:147], v12, s[24:27], s53 offen offset:0 nt
  buffer_load_dwordx4 v[148:151], v12, s[24:27], s53 offen offset:256 nt
  buffer_load_dwordx4 v[152:155], v12, s[24:27], s53 offen offset:512 nt
  buffer_load_dwordx4 v[156:159], v12, s[24:27], s53 offen offset:768 nt
  s_nop 1
  v_mfma_f32_16x16x32_bf16 v[52:55], v[84:87], v[36:39], 0
  v_mfma_f32_16x16x32_bf16 v[56:59], v[88:91], v[36:39], 0
  v_mfma_f32_16x16x32_bf16 v[60:63], v[92:95], v[36:39], 0
  v_mfma_f32_16x16x32_bf16 v[64:67], v[96:99], v[36:39], 0
  v_mfma_f32_16x16x32_bf16 v[68:71], v[100:103], v[36:39], 0
  v_mfma_f32_16x16x32_bf16 v[72:75], v[104:107], v[36:39], 0
  v_mfma_f32_16x16x32_bf16 v[76:79], v[108:111], v[36:39], 0
  v_mfma_f32_16x16x32_bf16 v[80:83], v[112:115], v[36:39], 0
  v_perm_b32 v84, v164, v160, s48
  v_perm_b32 v88, v164, v160, s49
  v_perm_b32 v85, v172, v168, s48
  v_perm_b32 v89, v172, v168, s49
  v_perm_b32 v86, v180, v176, s48
  v_perm_b32 v90, v180, v176, s49
  v_perm_b32 v87, v188, v184, s48
  v_perm_b32 v91, v188, v184, s49
  v_perm_b32 v92, v165, v161, s48
  v_perm_b32 v96, v165, v161, s49
  v_perm_b32 v93, v173, v169, s48
  v_perm_b32 v97, v173, v169, s49
  v_perm_b32 v94, v181, v177, s48
  v_perm_b32 v98, v181, v177, s49
  v_perm_b32 v95, v189, v185, s48
  v_perm_b32 v99, v189, v185, s49
  v_perm_b32 v100, v166, v162, s48
  v_perm_b32 v104, v166, v162, s49
  v_perm_b32 v101, v174, v170, s48
  v_perm_b32 v105, v174, v170, s49
  v_perm_b32 v102, v182, v178, s48
  v_perm_b32 v106, v182, v178, s49
  v_perm_b32 v103, v190, v186, s48
  v_perm_b32 v107, v190, v186, s49
  v_perm_b32 v108, v167, v163, s48
  v_perm_b32 v112, v167, v163, s49
  v_perm_b32 v109, v175, v171, s48
  v_perm_b32 v113, v175, v171, s49
  v_perm_b32 v110, v183, v179, s48
  v_perm_b32 v114, v183, v179, s49
  v_perm_b32 v111, v191, v187, s48
  v_perm_b32 v115, v191, v187, s49
  s_add_u32 s53, s93, 10
  s_and_b32 s53, s53, 15
  s_lshl_b32 s53, s53, 19
  s_add_u32 s53, s53, s51
  buffer_load_dwordx4 v[160:163], v12, s[24:27], s53 offen offset:0 nt
  buffer_load_dwordx4 v[164:167], v12, s[24:27], s53 offen offset:256 nt
  s_waitcnt vmcnt(31)
  buffer_load_dwordx4 v[168:171], v12, s[24:27], s53 offen offset:512 nt
  s_waitcnt vmcnt(31)
  buffer_load_dwordx4 v[172:175], v12, s[24:27], s53 offen offset:768 nt
  s_add_u32 s53, s93, 11
  s_and_b32 s53, s53, 15
  s_lshl_b32 s53, s53, 19
  s_add_u32 s53, s53, s51
  s_waitcnt vmcnt(31)
  buffer_load_dwordx4 v[176:179], v12, s[24:27], s53 offen offset:0 nt
  s_waitcnt vmcnt(31)
  buffer_load_dwordx4 v[180:183], v12, s[24:27], s53 offen offset:256 nt
  s_waitcnt vmcnt(31)
  buffer_load_dwordx4 v[184:187], v12, s[24:27], s53 offen offset:512 nt
  s_waitcnt vmcnt(31)
  buffer_load_dwordx4 v[188:191], v12, s[24:27], s53 offen offset:768 nt
  s_nop 1
  v_mfma_f32_16x16x32_bf16 v[52:55], v[84:87], v[44:47], v[52:55]
  v_mfma_f32_16x16x32_bf16 v[56:59], v[88:91], v[44:47], v[56:59]
  v_mfma_f32_16x16x32_bf16 v[60:63], v[92:95], v[44:47], v[60:63]
  v_mfma_f32_16x16x32_bf16 v[64:67], v[96:99], v[44:47], v[64:67]
  v_mfma_f32_16x16x32_bf16 v[68:71], v[100:103], v[44:47], v[68:71]
  v_mfma_f32_16x16x32_bf16 v[72:75], v[104:107], v[44:47], v[72:75]
  v_mfma_f32_16x16x32_bf16 v[76:79], v[108:111], v[44:47], v[76:79]
  v_mfma_f32_16x16x32_bf16 v[80:83], v[112:115], v[44:47], v[80:83]
  ds_read_b128 v[84:87], v8 offset:16384
  ds_read_b128 v[88:91], v9 offset:16384
  ds_read_b128 v[92:95], v10 offset:16384
  ds_read_b128 v[96:99], v11 offset:16384
  ds_read_b128 v[100:103], v8 offset:20480
  ds_read_b128 v[104:107], v9 offset:20480
  ds_read_b128 v[108:111], v10 offset:20480
  ds_read_b128 v[112:115], v11 offset:20480
  s_waitcnt lgkmcnt(4)
  v_mfma_f32_16x16x32_bf16 v[36:39], v[84:87], v[20:23], 0
  v_mfma_f32_16x16x32_bf16 v[36:39], v[88:91], v[24:27], v[36:39]
  v_mfma_f32_16x16x32_bf16 v[36:39], v[92:95], v[28:31], v[36:39]
  v_mfma_f32_16x16x32_bf16 v[36:39], v[96:99], v[32:35], v[36:39]
  s_waitcnt lgkmcnt(0)
  v_mfma_f32_16x16x32_bf16 v[40:43], v[100:103], v[20:23], 0
  v_mfma_f32_16x16x32_bf16 v[40:43], v[104:107], v[24:27], v[40:43]
  v_mfma_f32_16x16x32_bf16 v[40:43], v[108:111], v[28:31], v[40:43]
  v_mfma_f32_16x16x32_bf16 v[40:43], v[112:115], v[32:35], v[40:43]
  ds_read_b128 v[84:87], v8 offset:24576
  ds_read_b128 v[88:91], v9 offset:24576
  ds_read_b128 v[92:95], v10 offset:24576
  ds_read_b128 v[96:99], v11 offset:24576
  ds_read_b128 v[100:103], v8 offset:28672
  ds_read_b128 v[104:107], v9 offset:28672
  ds_read_b128 v[108:111], v10 offset:28672
  ds_read_b128 v[112:115], v11 offset:28672
  s_waitcnt lgkmcnt(4)
  v_mfma_f32_16x16x32_bf16 v[44:47], v[84:87], v[20:23], 0
  v_mfma_f32_16x16x32_bf16 v[44:47], v[88:91], v[24:27], v[44:47]
  v_mfma_f32_16x16x32_bf16 v[44:47], v[92:95], v[28:31], v[44:47]
  v_mfma_f32_16x16x32_bf16 v[44:47], v[96:99], v[32:35], v[44:47]
  s_waitcnt lgkmcnt(0)
  v_mfma_f32_16x16x32_bf16 v[48:51], v[100:103], v[20:23], 0
  v_mfma_f32_16x16x32_bf16 v[48:51], v[104:107], v[24:27], v[48:51]
  v_mfma_f32_16x16x32_bf16 v[48:51], v[108:111], v[28:31], v[48:51]
  v_mfma_f32_16x16x32_bf16 v[48:51], v[112:115], v[32:35], v[48:51]
  s_add_u32 s52, s93, 12
  s_and_b32 s52, s52, 15
  s_lshl_b32 s52, s52, 19
  s_add_u32 s52, s52, s51
  s_add_u32 m0, s54, 16384
  s_nop 0
  s_waitcnt vmcnt(31)
  buffer_load_dwordx4 v4, s[20:23], s52 offen offset:0 nt lds
  s_waitcnt vmcnt(31)
  buffer_load_dwordx4 v5, s[20:23], s52 offen offset:1024 nt lds
  s_waitcnt vmcnt(31)
  buffer_load_dwordx4 v6, s[20:23], s52 offen offset:2048 nt lds
  s_waitcnt vmcnt(31)
  buffer_load_dwordx4 v7, s[20:23], s52 offen offset:3072 nt lds
  s_add_u32 s52, s93, 13
  s_and_b32 s52, s52, 15
  s_lshl_b32 s52, s52, 19
  s_add_u32 s52, s52, s51
  s_add_u32 m0, s54, 20480
  s_nop 0
  s_waitcnt vmcnt(31)
  buffer_load_dwordx4 v4, s[20:23], s52 offen offset:0 nt lds
  s_waitcnt vmcnt(31)
  buffer_load_dwordx4 v5, s[20:23], s52 offen offset:1024 nt lds
  s_waitcnt vmcnt(31)
  buffer_load_dwordx4 v6, s[20:23], s52 offen offset:2048 nt lds
  s_waitcnt vmcnt(31)
  buffer_load_dwordx4 v7, s[20:23], s52 offen offset:3072 nt lds
  s_add_u32 s52, s93, 14
  s_and_b32 s52, s52, 15
  s_lshl_b32 s52, s52, 19
  s_add_u32 s52, s52, s51
  s_add_u32 m0, s54, 24576
  s_nop 0
  s_waitcnt vmcnt(31)
  buffer_load_dwordx4 v4, s[20:23], s52 offen offset:0 nt lds
  s_waitcnt vmcnt(31)
  buffer_load_dwordx4 v5, s[20:23], s52 offen offset:1024 nt lds
  s_waitcnt vmcnt(31)
  buffer_load_dwordx4 v6, s[20:23], s52 offen offset:2048 nt lds
  s_waitcnt vmcnt(31)
  buffer_load_dwordx4 v7, s[20:23], s52 offen offset:3072 nt lds
  s_add_u32 s52, s93, 15
  s_and_b32 s52, s52, 15
  s_lshl_b32 s52, s52, 19
  s_add_u32 s52, s52, s51
  s_add_u32 m0, s54, 28672
  s_nop 0
  s_waitcnt vmcnt(31)
  buffer_load_dwordx4 v4, s[20:23], s52 offen offset:0 nt lds
  s_waitcnt vmcnt(31)
  buffer_load_dwordx4 v5, s[20:23], s52 offen offset:1024 nt lds
  s_waitcnt vmcnt(31)
  buffer_load_dwordx4 v6, s[20:23], s52 offen offset:2048 nt lds
  s_waitcnt vmcnt(31)
  buffer_load_dwordx4 v7, s[20:23], s52 offen offset:3072 nt lds
  s_nop 1
  v_max3_f32 v17, v36, v37, v38
  v_max3_f32 v17, v17, v39, v40
  v_max3_f32 v17, v17, v41, v42
  v_max3_f32 v17, v17, v43, v44
  v_max3_f32 v17, v17, v45, v46
  v_max3_f32 v17, v17, v47, v48
  v_max3_f32 v17, v17, v49, v50
  v_max_f32 v17, v17, v51
  v_max_f32 v17, v17, v14
  v_mov_b32 v18, v17
  s_nop 1
  v_permlane16_swap_b32 v17, v18
  s_nop 1
  v_max_f32 v17, v17, v18
  v_mov_b32 v18, v17
  s_nop 1
  v_permlane32_swap_b32 v17, v18
  s_nop 1
  v_max_f32 v17, v17, v18
  v_sub_f32 v13, v14, v17
  v_mul_f32 v13, s50, v13
  v_exp_f32 v13, v13
  v_mov_b32 v14, v17
  v_mul_f32 v16, s50, v17
  v_fma_f32 v36, v36, s50, -v16
  v_fma_f32 v37, v37, s50, -v16
  v_fma_f32 v38, v38, s50, -v16
  v_fma_f32 v39, v39, s50, -v16
  v_fma_f32 v40, v40, s50, -v16
  v_fma_f32 v41, v41, s50, -v16
  v_fma_f32 v42, v42, s50, -v16
  v_fma_f32 v43, v43, s50, -v16
  v_fma_f32 v44, v44, s50, -v16
  v_fma_f32 v45, v45, s50, -v16
  v_fma_f32 v46, v46, s50, -v16
  v_fma_f32 v47, v47, s50, -v16
  v_fma_f32 v48, v48, s50, -v16
  v_fma_f32 v49, v49, s50, -v16
  v_fma_f32 v50, v50, s50, -v16
  v_fma_f32 v51, v51, s50, -v16
  v_exp_f32 v36, v36
  v_exp_f32 v37, v37
  v_exp_f32 v38, v38
  v_exp_f32 v39, v39
  v_exp_f32 v40, v40
  v_exp_f32 v41, v41
  v_exp_f32 v42, v42
  v_exp_f32 v43, v43
  v_exp_f32 v44, v44
  v_exp_f32 v45, v45
  v_exp_f32 v46, v46
  v_exp_f32 v47, v47
  v_exp_f32 v48, v48
  v_exp_f32 v49, v49
  v_exp_f32 v50, v50
  v_exp_f32 v51, v51
  v_mul_f32 v15, v15, v13
  v_mul_f32 v52, v52, v13
  v_mul_f32 v53, v53, v13
  v_mul_f32 v54, v54, v13
  v_mul_f32 v55, v55, v13
  v_mul_f32 v56, v56, v13
  v_mul_f32 v57, v57, v13
  v_mul_f32 v58, v58, v13
  v_mul_f32 v59, v59, v13
  v_mul_f32 v60, v60, v13
  v_mul_f32 v61, v61, v13
  v_mul_f32 v62, v62, v13
  v_mul_f32 v63, v63, v13
  v_mul_f32 v64, v64, v13
  v_mul_f32 v65, v65, v13
  v_mul_f32 v66, v66, v13
  v_mul_f32 v67, v67, v13
  v_mul_f32 v68, v68, v13
  v_mul_f32 v69, v69, v13
  v_mul_f32 v70, v70, v13
  v_mul_f32 v71, v71, v13
  v_mul_f32 v72, v72, v13
  v_mul_f32 v73, v73, v13
  v_mul_f32 v74, v74, v13
  v_mul_f32 v75, v75, v13
  v_mul_f32 v76, v76, v13
  v_mul_f32 v77, v77, v13
  v_mul_f32 v78, v78, v13
  v_mul_f32 v79, v79, v13
  v_mul_f32 v80, v80, v13
  v_mul_f32 v81, v81, v13
  v_mul_f32 v82, v82, v13
  v_mul_f32 v83, v83, v13
  v_add_f32 v15, v15, v36
  v_add_f32 v15, v15, v37
  v_add_f32 v15, v15, v38
  v_add_f32 v15, v15, v39
  v_add_f32 v15, v15, v40
  v_add_f32 v15, v15, v41
  v_add_f32 v15, v15, v42
  v_add_f32 v15, v15, v43
  v_add_f32 v15, v15, v44
  v_add_f32 v15, v15, v45
  v_add_f32 v15, v15, v46
  v_add_f32 v15, v15, v47
  v_add_f32 v15, v15, v48
  v_add_f32 v15, v15, v49
  v_add_f32 v15, v15, v50
  v_add_f32 v15, v15, v51
  v_cvt_pk_bf16_f32 v36, v36, v37
  v_cvt_pk_bf16_f32 v37, v38, v39
  v_cvt_pk_bf16_f32 v38, v40, v41
  v_cvt_pk_bf16_f32 v39, v42, v43
  v_cvt_pk_bf16_f32 v44, v44, v45
  v_cvt_pk_bf16_f32 v45, v46, v47
  v_cvt_pk_bf16_f32 v46, v48, v49
  v_cvt_pk_bf16_f32 v47, v50, v51
  v_perm_b32 v84, v196, v192, s48
  v_perm_b32 v88, v196, v192, s49
  v_perm_b32 v85, v204, v200, s48
  v_perm_b32 v89, v204, v200, s49
  v_perm_b32 v86, v212, v208, s48
  v_perm_b32 v90, v212, v208, s49
  v_perm_b32 v87, v220, v216, s48
  v_perm_b32 v91, v220, v216, s49
  v_perm_b32 v92, v197, v193, s48
  v_perm_b32 v96, v197, v193, s49
  v_perm_b32 v93, v205, v201, s48
  v_perm_b32 v97, v205, v201, s49
  v_perm_b32 v94, v213, v209, s48
  v_perm_b32 v98, v213, v209, s49
  v_perm_b32 v95, v221, v217, s48
  v_perm_b32 v99, v221, v217, s49
  v_perm_b32 v100, v198, v194, s48
  v_perm_b32 v104, v198, v194, s49
  v_perm_b32 v101, v206, v202, s48
  v_perm_b32 v105, v206, v202, s49
  v_perm_b32 v102, v214, v210, s48
  v_perm_b32 v106, v214, v210, s49
  v_perm_b32 v103, v222, v218, s48
  v_perm_b32 v107, v222, v218, s49
  v_perm_b32 v108, v199, v195, s48
  v_perm_b32 v112, v199, v195, s49
  v_perm_b32 v109, v207, v203, s48
  v_perm_b32 v113, v207, v203, s49
  v_perm_b32 v110, v215, v211, s48
  v_perm_b32 v114, v215, v211, s49
  v_perm_b32 v111, v223, v219, s48
  v_perm_b32 v115, v223, v219, s49
  s_add_u32 s53, s93, 12
  s_and_b32 s53, s53, 15
  s_lshl_b32 s53, s53, 19
  s_add_u32 s53, s53, s51
  s_waitcnt vmcnt(31)
  buffer_load_dwordx4 v[192:195], v12, s[24:27], s53 offen offset:0 nt
  s_waitcnt vmcnt(31)
  buffer_load_dwordx4 v[196:199], v12, s[24:27], s53 offen offset:256 nt
  s_waitcnt vmcnt(31)
  buffer_load_dwordx4 v[200:203], v12, s[24:27], s53 offen offset:512 nt
  s_waitcnt vmcnt(31)
  buffer_load_dwordx4 v[204:207], v12, s[24:27], s53 offen offset:768 nt
  s_add_u32 s53, s93, 13
  s_and_b32 s53, s53, 15
  s_lshl_b32 s53, s53, 19
  s_add_u32 s53, s53, s51
  s_waitcnt vmcnt(31)
  buffer_load_dwordx4 v[208:211], v12, s[24:27], s53 offen offset:0 nt
  s_waitcnt vmcnt(31)
  buffer_load_dwordx4 v[212:215], v12, s[24:27], s53 offen offset:256 nt
  s_waitcnt vmcnt(31)
  buffer_load_dwordx4 v[216:219], v12, s[24:27], s53 offen offset:512 nt
  s_waitcnt vmcnt(31)
  buffer_load_dwordx4 v[220:223], v12, s[24:27], s53 offen offset:768 nt
  s_nop 1
  v_mfma_f32_16x16x32_bf16 v[52:55], v[84:87], v[36:39], v[52:55]
  v_mfma_f32_16x16x32_bf16 v[56:59], v[88:91], v[36:39], v[56:59]
  v_mfma_f32_16x16x32_bf16 v[60:63], v[92:95], v[36:39], v[60:63]
  v_mfma_f32_16x16x32_bf16 v[64:67], v[96:99], v[36:39], v[64:67]
  v_mfma_f32_16x16x32_bf16 v[68:71], v[100:103], v[36:39], v[68:71]
  v_mfma_f32_16x16x32_bf16 v[72:75], v[104:107], v[36:39], v[72:75]
  v_mfma_f32_16x16x32_bf16 v[76:79], v[108:111], v[36:39], v[76:79]
  v_mfma_f32_16x16x32_bf16 v[80:83], v[112:115], v[36:39], v[80:83]
  v_perm_b32 v84, v228, v224, s48
  v_perm_b32 v88, v228, v224, s49
  v_perm_b32 v85, v236, v232, s48
  v_perm_b32 v89, v236, v232, s49
  v_perm_b32 v86, v244, v240, s48
  v_perm_b32 v90, v244, v240, s49
  v_perm_b32 v87, v252, v248, s48
  v_perm_b32 v91, v252, v248, s49
  v_perm_b32 v92, v229, v225, s48
  v_perm_b32 v96, v229, v225, s49
  v_perm_b32 v93, v237, v233, s48
  v_perm_b32 v97, v237, v233, s49
  v_perm_b32 v94, v245, v241, s48
  v_perm_b32 v98, v245, v241, s49
  v_perm_b32 v95, v253, v249, s48
  v_perm_b32 v99, v253, v249, s49
  v_perm_b32 v100, v230, v226, s48
  v_perm_b32 v104, v230, v226, s49
  v_perm_b32 v101, v238, v234, s48
  v_perm_b32 v105, v238, v234, s49
  v_perm_b32 v102, v246, v242, s48
  v_perm_b32 v106, v246, v242, s49
  v_perm_b32 v103, v254, v250, s48
  v_perm_b32 v107, v254, v250, s49
  v_perm_b32 v108, v231, v227, s48
  v_perm_b32 v112, v231, v227, s49
  v_perm_b32 v109, v239, v235, s48
  v_perm_b32 v113, v239, v235, s49
  v_perm_b32 v110, v247, v243, s48
  v_perm_b32 v114, v247, v243, s49
  v_perm_b32 v111, v255, v251, s48
  v_perm_b32 v115, v255, v251, s49
  s_add_u32 s53, s93, 14
  s_and_b32 s53, s53, 15
  s_lshl_b32 s53, s53, 19
  s_add_u32 s53, s53, s51
  s_waitcnt vmcnt(31)
  buffer_load_dwordx4 v[224:227], v12, s[24:27], s53 offen offset:0 nt
  s_waitcnt vmcnt(31)
  buffer_load_dwordx4 v[228:231], v12, s[24:27], s53 offen offset:256 nt
  s_waitcnt vmcnt(31)
  buffer_load_dwordx4 v[232:235], v12, s[24:27], s53 offen offset:512 nt
  s_waitcnt vmcnt(31)
  buffer_load_dwordx4 v[236:239], v12, s[24:27], s53 offen offset:768 nt
  s_add_u32 s53, s93, 15
  s_and_b32 s53, s53, 15
  s_lshl_b32 s53, s53, 19
  s_add_u32 s53, s53, s51
  s_waitcnt vmcnt(31)
  buffer_load_dwordx4 v[240:243], v12, s[24:27], s53 offen offset:0 nt
  s_waitcnt vmcnt(31)
  buffer_load_dwordx4 v[244:247], v12, s[24:27], s53 offen offset:256 nt
  s_waitcnt vmcnt(31)
  buffer_load_dwordx4 v[248:251], v12, s[24:27], s53 offen offset:512 nt
  s_waitcnt vmcnt(31)
  buffer_load_dwordx4 v[252:255], v12, s[24:27], s53 offen offset:768 nt
  s_nop 1
  v_mfma_f32_16x16x32_bf16 v[52:55], v[84:87], v[44:47], v[52:55]
  v_mfma_f32_16x16x32_bf16 v[56:59], v[88:91], v[44:47], v[56:59]
  v_mfma_f32_16x16x32_bf16 v[60:63], v[92:95], v[44:47], v[60:63]
  v_mfma_f32_16x16x32_bf16 v[64:67], v[96:99], v[44:47], v[64:67]
  v_mfma_f32_16x16x32_bf16 v[68:71], v[100:103], v[44:47], v[68:71]
  v_mfma_f32_16x16x32_bf16 v[72:75], v[104:107], v[44:47], v[72:75]
  v_mfma_f32_16x16x32_bf16 v[76:79], v[108:111], v[44:47], v[76:79]
  v_mfma_f32_16x16x32_bf16 v[80:83], v[112:115], v[44:47], v[80:83]
  ds_read_b128 v[84:87], v8 offset:0
  ds_read_b128 v[88:91], v9 offset:0
  ds_read_b128 v[92:95], v10 offset:0
  ds_read_b128 v[96:99], v11 offset:0
  ds_read_b128 v[100:103], v8 offset:4096
  ds_read_b128 v[104:107], v9 offset:4096
  ds_read_b128 v[108:111], v10 offset:4096
  ds_read_b128 v[112:115], v11 offset:4096
  s_waitcnt lgkmcnt(4)
  v_mfma_f32_16x16x32_bf16 v[36:39], v[84:87], v[20:23], 0
  v_mfma_f32_16x16x32_bf16 v[36:39], v[88:91], v[24:27], v[36:39]
  v_mfma_f32_16x16x32_bf16 v[36:39], v[92:95], v[28:31], v[36:39]
  v_mfma_f32_16x16x32_bf16 v[36:39], v[96:99], v[32:35], v[36:39]
  s_waitcnt lgkmcnt(0)
  v_mfma_f32_16x16x32_bf16 v[40:43], v[100:103], v[20:23], 0
  v_mfma_f32_16x16x32_bf16 v[40:43], v[104:107], v[24:27], v[40:43]
  v_mfma_f32_16x16x32_bf16 v[40:43], v[108:111], v[28:31], v[40:43]
  v_mfma_f32_16x16x32_bf16 v[40:43], v[112:115], v[32:35], v[40:43]
  ds_read_b128 v[84:87], v8 offset:8192
  ds_read_b128 v[88:91], v9 offset:8192
  ds_read_b128 v[92:95], v10 offset:8192
  ds_read_b128 v[96:99], v11 offset:8192
  ds_read_b128 v[100:103], v8 offset:12288
  ds_read_b128 v[104:107], v9 offset:12288
  ds_read_b128 v[108:111], v10 offset:12288
  ds_read_b128 v[112:115], v11 offset:12288
  s_waitcnt lgkmcnt(4)
  v_mfma_f32_16x16x32_bf16 v[44:47], v[84:87], v[20:23], 0
  v_mfma_f32_16x16x32_bf16 v[44:47], v[88:91], v[24:27], v[44:47]
  v_mfma_f32_16x16x32_bf16 v[44:47], v[92:95], v[28:31], v[44:47]
  v_mfma_f32_16x16x32_bf16 v[44:47], v[96:99], v[32:35], v[44:47]
  s_waitcnt lgkmcnt(0)
  v_mfma_f32_16x16x32_bf16 v[48:51], v[100:103], v[20:23], 0
  v_mfma_f32_16x16x32_bf16 v[48:51], v[104:107], v[24:27], v[48:51]
  v_mfma_f32_16x16x32_bf16 v[48:51], v[108:111], v[28:31], v[48:51]
  v_mfma_f32_16x16x32_bf16 v[48:51], v[112:115], v[32:35], v[48:51]
  s_nop 7
  s_nop 1
  v_max3_f32 v17, v36, v37, v38
  v_max3_f32 v17, v17, v39, v40
  v_max3_f32 v17, v17, v41, v42
  v_max3_f32 v17, v17, v43, v44
  v_max3_f32 v17, v17, v45, v46
  v_max3_f32 v17, v17, v47, v48
  v_max3_f32 v17, v17, v49, v50
  v_max_f32 v17, v17, v51
  v_max_f32 v17, v17, v14
  v_mov_b32 v18, v17
  s_nop 1
  v_permlane16_swap_b32 v17, v18
  s_nop 1
  v_max_f32 v17, v17, v18
  v_mov_b32 v18, v17
  s_nop 1
  v_permlane32_swap_b32 v17, v18
  s_nop 1
  v_max_f32 v17, v17, v18
  v_sub_f32 v13, v14, v17
  v_mul_f32 v13, s50, v13
  v_exp_f32 v13, v13
  v_mov_b32 v14, v17
  v_mul_f32 v16, s50, v17
  v_fma_f32 v36, v36, s50, -v16
  v_fma_f32 v37, v37, s50, -v16
  v_fma_f32 v38, v38, s50, -v16
  v_fma_f32 v39, v39, s50, -v16
  v_fma_f32 v40, v40, s50, -v16
  v_fma_f32 v41, v41, s50, -v16
  v_fma_f32 v42, v42, s50, -v16
  v_fma_f32 v43, v43, s50, -v16
  v_fma_f32 v44, v44, s50, -v16
  v_fma_f32 v45, v45, s50, -v16
  v_fma_f32 v46, v46, s50, -v16
  v_fma_f32 v47, v47, s50, -v16
  v_fma_f32 v48, v48, s50, -v16
  v_fma_f32 v49, v49, s50, -v16
  v_fma_f32 v50, v50, s50, -v16
  v_fma_f32 v51, v51, s50, -v16
  v_exp_f32 v36, v36
  v_exp_f32 v37, v37
  v_exp_f32 v38, v38
  v_exp_f32 v39, v39
  v_exp_f32 v40, v40
  v_exp_f32 v41, v41
  v_exp_f32 v42, v42
  v_exp_f32 v43, v43
  v_exp_f32 v44, v44
  v_exp_f32 v45, v45
  v_exp_f32 v46, v46
  v_exp_f32 v47, v47
  v_exp_f32 v48, v48
  v_exp_f32 v49, v49
  v_exp_f32 v50, v50
  v_exp_f32 v51, v51
  v_mul_f32 v15, v15, v13
  v_mul_f32 v52, v52, v13
  v_mul_f32 v53, v53, v13
  v_mul_f32 v54, v54, v13
  v_mul_f32 v55, v55, v13
  v_mul_f32 v56, v56, v13
  v_mul_f32 v57, v57, v13
  v_mul_f32 v58, v58, v13
  v_mul_f32 v59, v59, v13
  v_mul_f32 v60, v60, v13
  v_mul_f32 v61, v61, v13
  v_mul_f32 v62, v62, v13
  v_mul_f32 v63, v63, v13
  v_mul_f32 v64, v64, v13
  v_mul_f32 v65, v65, v13
  v_mul_f32 v66, v66, v13
  v_mul_f32 v67, v67, v13
  v_mul_f32 v68, v68, v13
  v_mul_f32 v69, v69, v13
  v_mul_f32 v70, v70, v13
  v_mul_f32 v71, v71, v13
  v_mul_f32 v72, v72, v13
  v_mul_f32 v73, v73, v13
  v_mul_f32 v74, v74, v13
  v_mul_f32 v75, v75, v13
  v_mul_f32 v76, v76, v13
  v_mul_f32 v77, v77, v13
  v_mul_f32 v78, v78, v13
  v_mul_f32 v79, v79, v13
  v_mul_f32 v80, v80, v13
  v_mul_f32 v81, v81, v13
  v_mul_f32 v82, v82, v13
  v_mul_f32 v83, v83, v13
  v_add_f32 v15, v15, v36
  v_add_f32 v15, v15, v37
  v_add_f32 v15, v15, v38
  v_add_f32 v15, v15, v39
  v_add_f32 v15, v15, v40
  v_add_f32 v15, v15, v41
  v_add_f32 v15, v15, v42
  v_add_f32 v15, v15, v43
  v_add_f32 v15, v15, v44
  v_add_f32 v15, v15, v45
  v_add_f32 v15, v15, v46
  v_add_f32 v15, v15, v47
  v_add_f32 v15, v15, v48
  v_add_f32 v15, v15, v49
  v_add_f32 v15, v15, v50
  v_add_f32 v15, v15, v51
  v_cvt_pk_bf16_f32 v36, v36, v37
  v_cvt_pk_bf16_f32 v37, v38, v39
  v_cvt_pk_bf16_f32 v38, v40, v41
  v_cvt_pk_bf16_f32 v39, v42, v43
  v_cvt_pk_bf16_f32 v44, v44, v45
  v_cvt_pk_bf16_f32 v45, v46, v47
  v_cvt_pk_bf16_f32 v46, v48, v49
  v_cvt_pk_bf16_f32 v47, v50, v51
  v_perm_b32 v84, v132, v128, s48
  v_perm_b32 v88, v132, v128, s49
  v_perm_b32 v85, v140, v136, s48
  v_perm_b32 v89, v140, v136, s49
  v_perm_b32 v86, v148, v144, s48
  v_perm_b32 v90, v148, v144, s49
  v_perm_b32 v87, v156, v152, s48
  v_perm_b32 v91, v156, v152, s49
  v_perm_b32 v92, v133, v129, s48
  v_perm_b32 v96, v133, v129, s49
  v_perm_b32 v93, v141, v137, s48
  v_perm_b32 v97, v141, v137, s49
  v_perm_b32 v94, v149, v145, s48
  v_perm_b32 v98, v149, v145, s49
  v_perm_b32 v95, v157, v153, s48
  v_perm_b32 v99, v157, v153, s49
  v_perm_b32 v100, v134, v130, s48
  v_perm_b32 v104, v134, v130, s49
  v_perm_b32 v101, v142, v138, s48
  v_perm_b32 v105, v142, v138, s49
  v_perm_b32 v102, v150, v146, s48
  v_perm_b32 v106, v150, v146, s49
  v_perm_b32 v103, v158, v154, s48
  v_perm_b32 v107, v158, v154, s49
  v_perm_b32 v108, v135, v131, s48
  v_perm_b32 v112, v135, v131, s49
  v_perm_b32 v109, v143, v139, s48
  v_perm_b32 v113, v143, v139, s49
  v_perm_b32 v110, v151, v147, s48
  v_perm_b32 v114, v151, v147, s49
  v_perm_b32 v111, v159, v155, s48
  v_perm_b32 v115, v159, v155, s49
  s_nop 1
  v_mfma_f32_16x16x32_bf16 v[52:55], v[84:87], v[36:39], v[52:55]
  v_mfma_f32_16x16x32_bf16 v[56:59], v[88:91], v[36:39], v[56:59]
  v_mfma_f32_16x16x32_bf16 v[60:63], v[92:95], v[36:39], v[60:63]
  v_mfma_f32_16x16x32_bf16 v[64:67], v[96:99], v[36:39], v[64:67]
  v_mfma_f32_16x16x32_bf16 v[68:71], v[100:103], v[36:39], v[68:71]
  v_mfma_f32_16x16x32_bf16 v[72:75], v[104:107], v[36:39], v[72:75]
  v_mfma_f32_16x16x32_bf16 v[76:79], v[108:111], v[36:39], v[76:79]
  v_mfma_f32_16x16x32_bf16 v[80:83], v[112:115], v[36:39], v[80:83]
  v_perm_b32 v84, v164, v160, s48
  v_perm_b32 v88, v164, v160, s49
  v_perm_b32 v85, v172, v168, s48
  v_perm_b32 v89, v172, v168, s49
  v_perm_b32 v86, v180, v176, s48
  v_perm_b32 v90, v180, v176, s49
  v_perm_b32 v87, v188, v184, s48
  v_perm_b32 v91, v188, v184, s49
  v_perm_b32 v92, v165, v161, s48
  v_perm_b32 v96, v165, v161, s49
  v_perm_b32 v93, v173, v169, s48
  v_perm_b32 v97, v173, v169, s49
  v_perm_b32 v94, v181, v177, s48
  v_perm_b32 v98, v181, v177, s49
  v_perm_b32 v95, v189, v185, s48
  v_perm_b32 v99, v189, v185, s49
  v_perm_b32 v100, v166, v162, s48
  v_perm_b32 v104, v166, v162, s49
  v_perm_b32 v101, v174, v170, s48
  v_perm_b32 v105, v174, v170, s49
  v_perm_b32 v102, v182, v178, s48
  v_perm_b32 v106, v182, v178, s49
  v_perm_b32 v103, v190, v186, s48
  v_perm_b32 v107, v190, v186, s49
  v_perm_b32 v108, v167, v163, s48
  v_perm_b32 v112, v167, v163, s49
  v_perm_b32 v109, v175, v171, s48
  v_perm_b32 v113, v175, v171, s49
  v_perm_b32 v110, v183, v179, s48
  v_perm_b32 v114, v183, v179, s49
  v_perm_b32 v111, v191, v187, s48
  v_perm_b32 v115, v191, v187, s49
  v_and_b32 v3, 1, v2
  v_lshlrev_b32 v3, 6, v3
  v_lshrrev_b32 v116, 1, v2
  v_add_u32 v3, v3, v116
  v_lshlrev_b32 v3, 11, v3
  v_lshl_add_u32 v116, v1, 4, v3
  s_lshl_b32 s64, s58, 7
  s_lshl_b32 s65, s59, 1
  s_add_u32 s64, s64, s65
  s_lshl_b32 s64, s64, 11
  s_lshl_b32 s65, s60, 10
  s_add_u32 s64, s64, s65
  s_lshl_b32 s65, s3, 8
  s_add_u32 s64, s64, s65
  s_add_u32 s53, s64, 0
  s_waitcnt vmcnt(31)
  buffer_load_dwordx4 v[128:131], v116, s[28:31], s53 offen nt
  s_add_u32 s53, s64, 16384
  s_waitcnt vmcnt(31)
  buffer_load_dwordx4 v[132:135], v116, s[28:31], s53 offen nt
  s_add_u32 s53, s64, 32768
  s_waitcnt vmcnt(31)
  buffer_load_dwordx4 v[136:139], v116, s[28:31], s53 offen nt
  s_add_u32 s53, s64, 49152
  s_waitcnt vmcnt(31)
  buffer_load_dwordx4 v[140:143], v116, s[28:31], s53 offen nt
  s_add_u32 s53, s64, 65536
  s_waitcnt vmcnt(31)
  buffer_load_dwordx4 v[144:147], v116, s[28:31], s53 offen nt
  s_add_u32 s53, s64, 81920
  s_waitcnt vmcnt(31)
  buffer_load_dwordx4 v[148:151], v116, s[28:31], s53 offen nt
  s_add_u32 s53, s64, 98304
  s_waitcnt vmcnt(31)
  buffer_load_dwordx4 v[152:155], v116, s[28:31], s53 offen nt
  s_add_u32 s53, s64, 114688
  s_waitcnt vmcnt(31)
  buffer_load_dwordx4 v[156:159], v116, s[28:31], s53 offen nt
  s_nop 1
  v_mfma_f32_16x16x32_bf16 v[52:55], v[84:87], v[44:47], v[52:55]
  v_mfma_f32_16x16x32_bf16 v[56:59], v[88:91], v[44:47], v[56:59]
  v_mfma_f32_16x16x32_bf16 v[60:63], v[92:95], v[44:47], v[60:63]
  v_mfma_f32_16x16x32_bf16 v[64:67], v[96:99], v[44:47], v[64:67]
  v_mfma_f32_16x16x32_bf16 v[68:71], v[100:103], v[44:47], v[68:71]
  v_mfma_f32_16x16x32_bf16 v[72:75], v[104:107], v[44:47], v[72:75]
  v_mfma_f32_16x16x32_bf16 v[76:79], v[108:111], v[44:47], v[76:79]
  v_mfma_f32_16x16x32_bf16 v[80:83], v[112:115], v[44:47], v[80:83]
  s_waitcnt vmcnt(24)
  ds_read_b128 v[84:87], v8 offset:16384
  ds_read_b128 v[88:91], v9 offset:16384
  ds_read_b128 v[92:95], v10 offset:16384
  ds_read_b128 v[96:99], v11 offset:16384
  ds_read_b128 v[100:103], v8 offset:20480
  ds_read_b128 v[104:107], v9 offset:20480
  ds_read_b128 v[108:111], v10 offset:20480
  ds_read_b128 v[112:115], v11 offset:20480
  s_waitcnt lgkmcnt(4)
  v_mfma_f32_16x16x32_bf16 v[36:39], v[84:87], v[20:23], 0
  v_mfma_f32_16x16x32_bf16 v[36:39], v[88:91], v[24:27], v[36:39]
  v_mfma_f32_16x16x32_bf16 v[36:39], v[92:95], v[28:31], v[36:39]
  v_mfma_f32_16x16x32_bf16 v[36:39], v[96:99], v[32:35], v[36:39]
  s_waitcnt lgkmcnt(0)
  v_mfma_f32_16x16x32_bf16 v[40:43], v[100:103], v[20:23], 0
  v_mfma_f32_16x16x32_bf16 v[40:43], v[104:107], v[24:27], v[40:43]
  v_mfma_f32_16x16x32_bf16 v[40:43], v[108:111], v[28:31], v[40:43]
  v_mfma_f32_16x16x32_bf16 v[40:43], v[112:115], v[32:35], v[40:43]
  ds_read_b128 v[84:87], v8 offset:24576
  ds_read_b128 v[88:91], v9 offset:24576
  ds_read_b128 v[92:95], v10 offset:24576
  ds_read_b128 v[96:99], v11 offset:24576
  ds_read_b128 v[100:103], v8 offset:28672
  ds_read_b128 v[104:107], v9 offset:28672
  ds_read_b128 v[108:111], v10 offset:28672
  ds_read_b128 v[112:115], v11 offset:28672
  s_waitcnt lgkmcnt(4)
  v_mfma_f32_16x16x32_bf16 v[44:47], v[84:87], v[20:23], 0
  v_mfma_f32_16x16x32_bf16 v[44:47], v[88:91], v[24:27], v[44:47]
  v_mfma_f32_16x16x32_bf16 v[44:47], v[92:95], v[28:31], v[44:47]
  v_mfma_f32_16x16x32_bf16 v[44:47], v[96:99], v[32:35], v[44:47]
  s_waitcnt lgkmcnt(0)
  v_mfma_f32_16x16x32_bf16 v[48:51], v[100:103], v[20:23], 0
  v_mfma_f32_16x16x32_bf16 v[48:51], v[104:107], v[24:27], v[48:51]
  v_mfma_f32_16x16x32_bf16 v[48:51], v[108:111], v[28:31], v[48:51]
  v_mfma_f32_16x16x32_bf16 v[48:51], v[112:115], v[32:35], v[48:51]
  s_nop 7
  s_nop 1
  v_max3_f32 v17, v36, v37, v38
  v_max3_f32 v17, v17, v39, v40
  v_max3_f32 v17, v17, v41, v42
  v_max3_f32 v17, v17, v43, v44
  v_max3_f32 v17, v17, v45, v46
  v_max3_f32 v17, v17, v47, v48
  v_max3_f32 v17, v17, v49, v50
  v_max_f32 v17, v17, v51
  v_max_f32 v17, v17, v14
  v_mov_b32 v18, v17
  s_nop 1
  v_permlane16_swap_b32 v17, v18
  s_nop 1
  v_max_f32 v17, v17, v18
  v_mov_b32 v18, v17
  s_nop 1
  v_permlane32_swap_b32 v17, v18
  s_nop 1
  v_max_f32 v17, v17, v18
  v_sub_f32 v13, v14, v17
  v_mul_f32 v13, s50, v13
  v_exp_f32 v13, v13
  v_mov_b32 v14, v17
  v_mul_f32 v16, s50, v17
  v_fma_f32 v36, v36, s50, -v16
  v_fma_f32 v37, v37, s50, -v16
  v_fma_f32 v38, v38, s50, -v16
  v_fma_f32 v39, v39, s50, -v16
  v_fma_f32 v40, v40, s50, -v16
  v_fma_f32 v41, v41, s50, -v16
  v_fma_f32 v42, v42, s50, -v16
  v_fma_f32 v43, v43, s50, -v16
  v_fma_f32 v44, v44, s50, -v16
  v_fma_f32 v45, v45, s50, -v16
  v_fma_f32 v46, v46, s50, -v16
  v_fma_f32 v47, v47, s50, -v16
  v_fma_f32 v48, v48, s50, -v16
  v_fma_f32 v49, v49, s50, -v16
  v_fma_f32 v50, v50, s50, -v16
  v_fma_f32 v51, v51, s50, -v16
  v_exp_f32 v36, v36
  v_exp_f32 v37, v37
  v_exp_f32 v38, v38
  v_exp_f32 v39, v39
  v_exp_f32 v40, v40
  v_exp_f32 v41, v41
  v_exp_f32 v42, v42
  v_exp_f32 v43, v43
  v_exp_f32 v44, v44
  v_exp_f32 v45, v45
  v_exp_f32 v46, v46
  v_exp_f32 v47, v47
  v_exp_f32 v48, v48
  v_exp_f32 v49, v49
  v_exp_f32 v50, v50
  v_exp_f32 v51, v51
  v_mul_f32 v15, v15, v13
  v_mul_f32 v52, v52, v13
  v_mul_f32 v53, v53, v13
  v_mul_f32 v54, v54, v13
  v_mul_f32 v55, v55, v13
  v_mul_f32 v56, v56, v13
  v_mul_f32 v57, v57, v13
  v_mul_f32 v58, v58, v13
  v_mul_f32 v59, v59, v13
  v_mul_f32 v60, v60, v13
  v_mul_f32 v61, v61, v13
  v_mul_f32 v62, v62, v13
  v_mul_f32 v63, v63, v13
  v_mul_f32 v64, v64, v13
  v_mul_f32 v65, v65, v13
  v_mul_f32 v66, v66, v13
  v_mul_f32 v67, v67, v13
  v_mul_f32 v68, v68, v13
  v_mul_f32 v69, v69, v13
  v_mul_f32 v70, v70, v13
  v_mul_f32 v71, v71, v13
  v_mul_f32 v72, v72, v13
  v_mul_f32 v73, v73, v13
  v_mul_f32 v74, v74, v13
  v_mul_f32 v75, v75, v13
  v_mul_f32 v76, v76, v13
  v_mul_f32 v77, v77, v13
  v_mul_f32 v78, v78, v13
  v_mul_f32 v79, v79, v13
  v_mul_f32 v80, v80, v13
  v_mul_f32 v81, v81, v13
  v_mul_f32 v82, v82, v13
  v_mul_f32 v83, v83, v13
  v_add_f32 v15, v15, v36
  v_add_f32 v15, v15, v37
  v_add_f32 v15, v15, v38
  v_add_f32 v15, v15, v39
  v_add_f32 v15, v15, v40
  v_add_f32 v15, v15, v41
  v_add_f32 v15, v15, v42
  v_add_f32 v15, v15, v43
  v_add_f32 v15, v15, v44
  v_add_f32 v15, v15, v45
  v_add_f32 v15, v15, v46
  v_add_f32 v15, v15, v47
  v_add_f32 v15, v15, v48
  v_add_f32 v15, v15, v49
  v_add_f32 v15, v15, v50
  v_add_f32 v15, v15, v51
  v_cvt_pk_bf16_f32 v36, v36, v37
  v_cvt_pk_bf16_f32 v37, v38, v39
  v_cvt_pk_bf16_f32 v38, v40, v41
  v_cvt_pk_bf16_f32 v39, v42, v43
  v_cvt_pk_bf16_f32 v44, v44, v45
  v_cvt_pk_bf16_f32 v45, v46, v47
  v_cvt_pk_bf16_f32 v46, v48, v49
  v_cvt_pk_bf16_f32 v47, v50, v51
  v_mov_b32 v18, v15
  s_nop 1
  v_permlane16_swap_b32 v15, v18
  s_nop 1
  v_add_f32 v15, v15, v18
  v_mov_b32 v18, v15
  s_nop 1
  v_permlane32_swap_b32 v15, v18
  s_nop 1
  v_add_f32 v15, v15, v18
  v_mul_u32_u24 v120, 528, v1
  v_lshl_add_u32 v120, v2, 4, v120
  v_add_u32 v120, s54, v120
  s_lshl_b32 s64, s3, 6
  s_add_u32 s64, s64, 133120
  v_lshl_add_u32 v18, v1, 3, s64
  s_mov_b64 exec, 0xff
  ds_write_b64 v18, v[14:15]
  s_mov_b64 exec, -1
  v_lshrrev_b32 v18, 5, v0
  s_lshl_b32 s64, s3, 1
  v_add_u32 v18, s64, v18
  v_and_b32 v19, 31, v0
  v_mul_u32_u24 v121, 528, v18
  v_lshl_add_u32 v121, v19, 4, v121
  v_add_u32 v119, 65536, v121
  v_lshlrev_b32 v122, 3, v18
  v_add_u32 v122, 133120, v122
  s_mov_b32 s64, 40960
  v_mul_lo_u32 v117, v18, s64
  v_and_b32 v3, 7, v19
  v_lshl_add_u32 v118, v3, 4, v117
  v_lshl_add_u32 v117, v19, 4, v117
  s_waitcnt vmcnt(16)
  v_perm_b32 v84, v196, v192, s48
  v_perm_b32 v88, v196, v192, s49
  v_perm_b32 v85, v204, v200, s48
  v_perm_b32 v89, v204, v200, s49
  v_perm_b32 v86, v212, v208, s48
  v_perm_b32 v90, v212, v208, s49
  v_perm_b32 v87, v220, v216, s48
  v_perm_b32 v91, v220, v216, s49
  v_perm_b32 v92, v197, v193, s48
  v_perm_b32 v96, v197, v193, s49
  v_perm_b32 v93, v205, v201, s48
  v_perm_b32 v97, v205, v201, s49
  v_perm_b32 v94, v213, v209, s48
  v_perm_b32 v98, v213, v209, s49
  v_perm_b32 v95, v221, v217, s48
  v_perm_b32 v99, v221, v217, s49
  v_perm_b32 v100, v198, v194, s48
  v_perm_b32 v104, v198, v194, s49
  v_perm_b32 v101, v206, v202, s48
  v_perm_b32 v105, v206, v202, s49
  v_perm_b32 v102, v214, v210, s48
  v_perm_b32 v106, v214, v210, s49
  v_perm_b32 v103, v222, v218, s48
  v_perm_b32 v107, v222, v218, s49
  v_perm_b32 v108, v199, v195, s48
  v_perm_b32 v112, v199, v195, s49
  v_perm_b32 v109, v207, v203, s48
  v_perm_b32 v113, v207, v203, s49
  v_perm_b32 v110, v215, v211, s48
  v_perm_b32 v114, v215, v211, s49
  v_perm_b32 v111, v223, v219, s48
  v_perm_b32 v115, v223, v219, s49
  s_nop 1
  v_mfma_f32_16x16x32_bf16 v[52:55], v[84:87], v[36:39], v[52:55]
  v_mfma_f32_16x16x32_bf16 v[56:59], v[88:91], v[36:39], v[56:59]
  v_mfma_f32_16x16x32_bf16 v[60:63], v[92:95], v[36:39], v[60:63]
  v_mfma_f32_16x16x32_bf16 v[64:67], v[96:99], v[36:39], v[64:67]
  v_mfma_f32_16x16x32_bf16 v[68:71], v[100:103], v[36:39], v[68:71]
  v_mfma_f32_16x16x32_bf16 v[72:75], v[104:107], v[36:39], v[72:75]
  v_mfma_f32_16x16x32_bf16 v[76:79], v[108:111], v[36:39], v[76:79]
  v_mfma_f32_16x16x32_bf16 v[80:83], v[112:115], v[36:39], v[80:83]
  s_waitcnt vmcnt(8)
  v_perm_b32 v84, v228, v224, s48
  v_perm_b32 v88, v228, v224, s49
  v_perm_b32 v85, v236, v232, s48
  v_perm_b32 v89, v236, v232, s49
  v_perm_b32 v86, v244, v240, s48
  v_perm_b32 v90, v244, v240, s49
  v_perm_b32 v87, v252, v248, s48
  v_perm_b32 v91, v252, v248, s49
  v_perm_b32 v92, v229, v225, s48
  v_perm_b32 v96, v229, v225, s49
  v_perm_b32 v93, v237, v233, s48
  v_perm_b32 v97, v237, v233, s49
  v_perm_b32 v94, v245, v241, s48
  v_perm_b32 v98, v245, v241, s49
  v_perm_b32 v95, v253, v249, s48
  v_perm_b32 v99, v253, v249, s49
  v_perm_b32 v100, v230, v226, s48
  v_perm_b32 v104, v230, v226, s49
  v_perm_b32 v101, v238, v234, s48
  v_perm_b32 v105, v238, v234, s49
  v_perm_b32 v102, v246, v242, s48
  v_perm_b32 v106, v246, v242, s49
  v_perm_b32 v103, v254, v250, s48
  v_perm_b32 v107, v254, v250, s49
  v_perm_b32 v108, v231, v227, s48
  v_perm_b32 v112, v231, v227, s49
  v_perm_b32 v109, v239, v235, s48
  v_perm_b32 v113, v239, v235, s49
  v_perm_b32 v110, v247, v243, s48
  v_perm_b32 v114, v247, v243, s49
  v_perm_b32 v111, v255, v251, s48
  v_perm_b32 v115, v255, v251, s49
  s_nop 1
  v_mfma_f32_16x16x32_bf16 v[52:55], v[84:87], v[44:47], v[52:55]
  v_mfma_f32_16x16x32_bf16 v[56:59], v[88:91], v[44:47], v[56:59]
  v_mfma_f32_16x16x32_bf16 v[60:63], v[92:95], v[44:47], v[60:63]
  v_mfma_f32_16x16x32_bf16 v[64:67], v[96:99], v[44:47], v[64:67]
  v_mfma_f32_16x16x32_bf16 v[68:71], v[100:103], v[44:47], v[68:71]
  v_mfma_f32_16x16x32_bf16 v[72:75], v[104:107], v[44:47], v[72:75]
  v_mfma_f32_16x16x32_bf16 v[76:79], v[108:111], v[44:47], v[76:79]
  v_mfma_f32_16x16x32_bf16 v[80:83], v[112:115], v[44:47], v[80:83]
  s_mov_b32 exec_lo, 0x00ff00ff
  s_mov_b32 exec_hi, 0x00ff00ff
  s_nop 0
  ds_write_b128 v120, v[52:55] offset:0
  ds_write_b128 v120, v[56:59] offset:64
  ds_write_b128 v120, v[60:63] offset:128
  ds_write_b128 v120, v[64:67] offset:192
  ds_write_b128 v120, v[68:71] offset:256
  ds_write_b128 v120, v[72:75] offset:320
  ds_write_b128 v120, v[76:79] offset:384
  ds_write_b128 v120, v[80:83] offset:448
  s_mov_b64 exec, -1
  s_waitcnt lgkmcnt(0)
  s_barrier
  ds_read_b64 v[36:37], v122 offset:0
  ds_read_b64 v[38:39], v122 offset:64
  ds_read_b64 v[40:41], v122 offset:128
  ds_read_b64 v[42:43], v122 offset:192
  ds_read_b128 v[52:55], v121 offset:0
  ds_read_b128 v[56:59], v121 offset:32768
  ds_read_b128 v[60:63], v119 offset:0
  ds_read_b128 v[64:67], v119 offset:32768
  s_waitcnt lgkmcnt(4)
  v_max3_f32 v44, v36, v38, v40
  v_max_f32 v44, v44, v42
  v_sub_f32 v36, v36, v44
  v_sub_f32 v38, v38, v44
  v_sub_f32 v40, v40, v44
  v_sub_f32 v42, v42, v44
  v_mul_f32 v36, s50, v36
  v_mul_f32 v38, s50, v38
  v_mul_f32 v40, s50, v40
  v_mul_f32 v42, s50, v42
  v_exp_f32 v36, v36
  v_exp_f32 v38, v38
  v_exp_f32 v40, v40
  v_exp_f32 v42, v42
  v_mul_f32 v44, s50, v44
  s_waitcnt lgkmcnt(0)
  v_mul_f32 v52, v36, v52
  v_mul_f32 v53, v36, v53
  v_mul_f32 v54, v36, v54
  v_mul_f32 v55, v36, v55
  v_fmac_f32 v52, v38, v56
  v_fmac_f32 v53, v38, v57
  v_fmac_f32 v54, v38, v58
  v_fmac_f32 v55, v38, v59
  v_fmac_f32 v52, v40, v60
  v_fmac_f32 v53, v40, v61
  v_fmac_f32 v54, v40, v62
  v_fmac_f32 v55, v40, v63
  v_fmac_f32 v52, v42, v64
  v_fmac_f32 v53, v42, v65
  v_fmac_f32 v54, v42, v66
  v_fmac_f32 v55, v42, v67
  buffer_store_dwordx4 v[52:55], v117, s[32:35], s66 offen sc1
  v_mul_f32 v45, v36, v37
  v_fmac_f32 v45, v38, v39
  v_fmac_f32 v45, v40, v41
  v_fmac_f32 v45, v42, v43
  v_mov_b32 v46, v44
  v_mov_b32 v47, v45
  s_mov_b32 exec_lo, 0xff
  s_mov_b32 exec_hi, 0xff
  buffer_store_dwordx4 v[44:47], v118, s[32:35], s66 offen offset:512 sc1
  s_mov_b64 exec, -1
  v_lshrrev_b32 v3, 5, v0
  v_lshlrev_b32 v117, 12, v3
  v_lshl_add_u32 v117, v1, 5, v117
  v_and_b32 v3, 1, v2
  v_lshl_add_u32 v117, v3, 4, v117
  s_lshl_b32 s64, s3, 9
  s_add_u32 s64, s64, s67
  v_and_b32 v3, 1, v1
  v_lshlrev_b32 v3, 6, v3
  v_lshl_add_u32 v3, v2, 4, v3
  v_add_u32 v3, 133376, v3
  s_waitcnt vmcnt(2)
  v_perm_b32 v84, v132, v128, s48
  v_perm_b32 v88, v132, v128, s49
  v_perm_b32 v85, v140, v136, s48
  v_perm_b32 v89, v140, v136, s49
  v_perm_b32 v86, v148, v144, s48
  v_perm_b32 v90, v148, v144, s49
  v_perm_b32 v87, v156, v152, s48
  v_perm_b32 v91, v156, v152, s49
  v_perm_b32 v92, v133, v129, s48
  v_perm_b32 v96, v133, v129, s49
  v_perm_b32 v93, v141, v137, s48
  v_perm_b32 v97, v141, v137, s49
  v_perm_b32 v94, v149, v145, s48
  v_perm_b32 v98, v149, v145, s49
  v_perm_b32 v95, v157, v153, s48
  v_perm_b32 v99, v157, v153, s49
  v_perm_b32 v100, v134, v130, s48
  v_perm_b32 v104, v134, v130, s49
  v_perm_b32 v101, v142, v138, s48
  v_perm_b32 v105, v142, v138, s49
  v_perm_b32 v102, v150, v146, s48
  v_perm_b32 v106, v150, v146, s49
  v_perm_b32 v103, v158, v154, s48
  v_perm_b32 v107, v158, v154, s49
  v_perm_b32 v108, v135, v131, s48
  v_perm_b32 v112, v135, v131, s49
  v_perm_b32 v109, v143, v139, s48
  v_perm_b32 v113, v143, v139, s49
  v_perm_b32 v110, v151, v147, s48
  v_perm_b32 v114, v151, v147, s49
  v_perm_b32 v111, v159, v155, s48
  v_perm_b32 v115, v159, v155, s49
  s_barrier
  ds_read_b128 v[20:23], v3
  s_waitcnt lgkmcnt(0)
  v_mfma_f32_16x16x32_bf16 v[52:55], v[20:23], v[84:87], 0
  v_mfma_f32_16x16x32_bf16 v[56:59], v[20:23], v[88:91], 0
  v_mfma_f32_16x16x32_bf16 v[60:63], v[20:23], v[92:95], 0
  v_mfma_f32_16x16x32_bf16 v[64:67], v[20:23], v[96:99], 0
  v_mfma_f32_16x16x32_bf16 v[68:71], v[20:23], v[100:103], 0
  v_mfma_f32_16x16x32_bf16 v[72:75], v[20:23], v[104:107], 0
  v_mfma_f32_16x16x32_bf16 v[76:79], v[20:23], v[108:111], 0
  v_mfma_f32_16x16x32_bf16 v[80:83], v[20:23], v[112:115], 0
  s_nop 4
  v_mov_b32 v36, v52
  v_mov_b32 v37, v56
  v_mov_b32 v38, v60
  v_mov_b32 v39, v64
  s_nop 0
  v_permlane16_swap_b32 v36, v68
  v_permlane16_swap_b32 v37, v72
  v_permlane16_swap_b32 v38, v76
  v_permlane16_swap_b32 v39, v80
  v_permlane16_swap_b32 v53, v69
  v_permlane16_swap_b32 v57, v73
  v_permlane16_swap_b32 v61, v77
  v_permlane16_swap_b32 v65, v81
  s_nop 0
  v_permlane32_swap_b32 v36, v53
  v_permlane32_swap_b32 v37, v57
  v_permlane32_swap_b32 v38, v61
  v_permlane32_swap_b32 v39, v65
  s_nop 0
  buffer_store_dwordx4 v[36:39], v117, s[32:35], s64 offen sc1
  s_endpgm
L_helper:
  s_setprio 3
  s_mov_b32 s28, s10
  s_and_b32 s29, s11, 0xffff
  s_mov_b32 s30, 8388608
  s_mov_b32 s31, 0x20000
  v_mov_b32 v3, 0
  s_mov_b32 s52, 655360
  buffer_load_dword v16, v3, s[32:35], s52 offen sc1
  v_lshlrev_b32 v3, 4, v1
  v_lshl_add_u32 v4, v2, 16, v3
  s_lshl_b32 s64, s63, 20
  s_lshl_b32 s65, s58, 8
  s_add_u32 s64, s64, s65
  s_add_u32 s52, s64, 0
  buffer_load_dwordx4 v[128:131], v4, s[28:31], s52 offen nt
  s_add_u32 s52, s64, 8192
  buffer_load_dwordx4 v[132:135], v4, s[28:31], s52 offen nt
  s_add_u32 s52, s64, 16384
  buffer_load_dwordx4 v[136:139], v4, s[28:31], s52 offen nt
  s_add_u32 s52, s64, 24576
  buffer_load_dwordx4 v[140:143], v4, s[28:31], s52 offen nt
  s_add_u32 s52, s64, 32768
  buffer_load_dwordx4 v[144:147], v4, s[28:31], s52 offen nt
  s_add_u32 s52, s64, 40960
  buffer_load_dwordx4 v[148:151], v4, s[28:31], s52 offen nt
  s_add_u32 s52, s64, 49152
  buffer_load_dwordx4 v[152:155], v4, s[28:31], s52 offen nt
  s_add_u32 s52, s64, 57344
  buffer_load_dwordx4 v[156:159], v4, s[28:31], s52 offen nt
  s_add_u32 s52, s64, 262144
  buffer_load_dwordx4 v[160:163], v4, s[28:31], s52 offen nt
  s_add_u32 s52, s64, 270336
  buffer_load_dwordx4 v[164:167], v4, s[28:31], s52 offen nt
  s_add_u32 s52, s64, 278528
  buffer_load_dwordx4 v[168:171], v4, s[28:31], s52 offen nt
  s_add_u32 s52, s64, 286720
  buffer_load_dwordx4 v[172:175], v4, s[28:31], s52 offen nt
  s_add_u32 s52, s64, 294912
  buffer_load_dwordx4 v[176:179], v4, s[28:31], s52 offen nt
  s_add_u32 s52, s64, 303104
  buffer_load_dwordx4 v[180:183], v4, s[28:31], s52 offen nt
  s_add_u32 s52, s64, 311296
  buffer_load_dwordx4 v[184:187], v4, s[28:31], s52 offen nt
  s_add_u32 s52, s64, 319488
  buffer_load_dwordx4 v[188:191], v4, s[28:31], s52 offen nt
  s_add_u32 s52, s64, 524288
  buffer_load_dwordx4 v[192:195], v4, s[28:31], s52 offen nt
  s_add_u32 s52, s64, 532480
  buffer_load_dwordx4 v[196:199], v4, s[28:31], s52 offen nt
  s_add_u32 s52, s64, 540672
  buffer_load_dwordx4 v[200:203], v4, s[28:31], s52 offen nt
  s_add_u32 s52, s64, 548864
  buffer_load_dwordx4 v[204:207], v4, s[28:31], s52 offen nt
  s_add_u32 s52, s64, 557056
  buffer_load_dwordx4 v[208:211], v4, s[28:31], s52 offen nt
  s_add_u32 s52, s64, 565248
  buffer_load_dwordx4 v[212:215], v4, s[28:31], s52 offen nt
  s_add_u32 s52, s64, 573440
  buffer_load_dwordx4 v[216:219], v4, s[28:31], s52 offen nt
  s_add_u32 s52, s64, 581632
  buffer_load_dwordx4 v[220:223], v4, s[28:31], s52 offen nt
  s_add_u32 s52, s64, 786432
  buffer_load_dwordx4 v[224:227], v4, s[28:31], s52 offen nt
  s_add_u32 s52, s64, 794624
  buffer_load_dwordx4 v[228:231], v4, s[28:31], s52 offen nt
  s_add_u32 s52, s64, 802816
  buffer_load_dwordx4 v[232:235], v4, s[28:31], s52 offen nt
  s_add_u32 s52, s64, 811008
  buffer_load_dwordx4 v[236:239], v4, s[28:31], s52 offen nt
  s_add_u32 s52, s64, 819200
  buffer_load_dwordx4 v[240:243], v4, s[28:31], s52 offen nt
  s_add_u32 s52, s64, 827392
  buffer_load_dwordx4 v[244:247], v4, s[28:31], s52 offen nt
  s_add_u32 s52, s64, 835584
  buffer_load_dwordx4 v[248:251], v4, s[28:31], s52 offen nt
  s_add_u32 s52, s64, 843776
  buffer_load_dwordx4 v[252:255], v4, s[28:31], s52 offen nt
  s_mov_b32 s36, s4
  s_and_b32 s37, s5, 0xffff
  s_mov_b32 s38, 4096
  s_mov_b32 s39, 0x20000
  v_and_b32 v3, 1, v1
  v_lshlrev_b32 v3, 11, v3
  v_lshl_add_u32 v3, v2, 4, v3
  s_lshl_b32 s64, s63, 8
  buffer_load_dwordx4 v[20:23], v3, s[36:39], s64 offen offset:0
  buffer_load_dwordx4 v[24:27], v3, s[36:39], s64 offen offset:64
  buffer_load_dwordx4 v[28:31], v3, s[36:39], s64 offen offset:128
  buffer_load_dwordx4 v[32:35], v3, s[36:39], s64 offen offset:192
  s_barrier
  s_mov_b32 s40, s14
  s_and_b32 s41, s15, 0xffff
  s_mov_b32 s42, 4096
  s_mov_b32 s43, 0x20000
  s_mov_b32 s44, s16
  s_and_b32 s45, s17, 0xffff
  s_mov_b32 s46, 256
  s_mov_b32 s47, 0x20000
  v_lshrrev_b32 v3, 5, v0
  v_lshlrev_b32 v4, 9, v3
  v_lshl_add_u32 v4, v1, 5, v4
  v_and_b32 v3, 1, v2
  v_lshl_add_u32 v4, v3, 4, v4
  v_add_u32 v4, 133632, v4
  v_lshlrev_b32 v5, 3, v0
  v_add_u32 v5, 133632, v5
  v_lshlrev_b32 v6, 4, v0
  v_lshrrev_b32 v3, 3, v0
  v_lshlrev_b32 v7, 11, v3
  v_and_b32 v3, 7, v0
  v_lshl_add_u32 v7, v3, 4, v7
  s_lshl_b32 s64, s58, 3
  s_add_u32 s64, s64, s63
  s_lshl_b32 s54, s64, 7
  s_add_u32 s54, s54, 524288
  s_lshl_b32 s64, s64, 11
  s_lshl_b32 s65, s58, 14
  s_lshl_b32 s52, s63, 7
  s_add_u32 s65, s65, s52
  s_waitcnt vmcnt(0)
  v_readfirstlane_b32 s68, v16
  v_perm_b32 v84, v132, v128, s48
  v_perm_b32 v88, v132, v128, s49
  v_perm_b32 v85, v140, v136, s48
  v_perm_b32 v89, v140, v136, s49
  v_perm_b32 v86, v148, v144, s48
  v_perm_b32 v90, v148, v144, s49
  v_perm_b32 v87, v156, v152, s48
  v_perm_b32 v91, v156, v152, s49
  v_perm_b32 v92, v133, v129, s48
  v_perm_b32 v96, v133, v129, s49
  v_perm_b32 v93, v141, v137, s48
  v_perm_b32 v97, v141, v137, s49
  v_perm_b32 v94, v149, v145, s48
  v_perm_b32 v98, v149, v145, s49
  v_perm_b32 v95, v157, v153, s48
  v_perm_b32 v99, v157, v153, s49
  v_perm_b32 v100, v134, v130, s48
  v_perm_b32 v104, v134, v130, s49
  v_perm_b32 v101, v142, v138, s48
  v_perm_b32 v105, v142, v138, s49
  v_perm_b32 v102, v150, v146, s48
  v_perm_b32 v106, v150, v146, s49
  v_perm_b32 v103, v158, v154, s48
  v_perm_b32 v107, v158, v154, s49
  v_perm_b32 v108, v135, v131, s48
  v_perm_b32 v112, v135, v131, s49
  v_perm_b32 v109, v143, v139, s48
  v_perm_b32 v113, v143, v139, s49
  v_perm_b32 v110, v151, v147, s48
  v_perm_b32 v114, v151, v147, s49
  v_perm_b32 v111, v159, v155, s48
  v_perm_b32 v115, v159, v155, s49
  s_nop 1
  v_mfma_f32_16x16x32_bf16 v[52:55], v[20:23], v[84:87], 0
  v_mfma_f32_16x16x32_bf16 v[56:59], v[20:23], v[88:91], 0
  v_mfma_f32_16x16x32_bf16 v[60:63], v[20:23], v[92:95], 0
  v_mfma_f32_16x16x32_bf16 v[64:67], v[20:23], v[96:99], 0
  v_mfma_f32_16x16x32_bf16 v[68:71], v[20:23], v[100:103], 0
  v_mfma_f32_16x16x32_bf16 v[72:75], v[20:23], v[104:107], 0
  v_mfma_f32_16x16x32_bf16 v[76:79], v[20:23], v[108:111], 0
  v_mfma_f32_16x16x32_bf16 v[80:83], v[20:23], v[112:115], 0
  v_perm_b32 v84, v164, v160, s48
  v_perm_b32 v88, v164, v160, s49
  v_perm_b32 v85, v172, v168, s48
  v_perm_b32 v89, v172, v168, s49
  v_perm_b32 v86, v180, v176, s48
  v_perm_b32 v90, v180, v176, s49
  v_perm_b32 v87, v188, v184, s48
  v_perm_b32 v91, v188, v184, s49
  v_perm_b32 v92, v165, v161, s48
  v_perm_b32 v96, v165, v161, s49
  v_perm_b32 v93, v173, v169, s48
  v_perm_b32 v97, v173, v169, s49
  v_perm_b32 v94, v181, v177, s48
  v_perm_b32 v98, v181, v177, s49
  v_perm_b32 v95, v189, v185, s48
  v_perm_b32 v99, v189, v185, s49
  v_perm_b32 v100, v166, v162, s48
  v_perm_b32 v104, v166, v162, s49
  v_perm_b32 v101, v174, v170, s48
  v_perm_b32 v105, v174, v170, s49
  v_perm_b32 v102, v182, v178, s48
  v_perm_b32 v106, v182, v178, s49
  v_perm_b32 v103, v190, v186, s48
  v_perm_b32 v107, v190, v186, s49
  v_perm_b32 v108, v167, v163, s48
  v_perm_b32 v112, v167, v163, s49
  v_perm_b32 v109, v175, v171, s48
  v_perm_b32 v113, v175, v171, s49
  v_perm_b32 v110, v183, v179, s48
  v_perm_b32 v114, v183, v179, s49
  v_perm_b32 v111, v191, v187, s48
  v_perm_b32 v115, v191, v187, s49
  s_nop 1
  v_mfma_f32_16x16x32_bf16 v[52:55], v[24:27], v[84:87], v[52:55]
  v_mfma_f32_16x16x32_bf16 v[56:59], v[24:27], v[88:91], v[56:59]
  v_mfma_f32_16x16x32_bf16 v[60:63], v[24:27], v[92:95], v[60:63]
  v_mfma_f32_16x16x32_bf16 v[64:67], v[24:27], v[96:99], v[64:67]
  v_mfma_f32_16x16x32_bf16 v[68:71], v[24:27], v[100:103], v[68:71]
  v_mfma_f32_16x16x32_bf16 v[72:75], v[24:27], v[104:107], v[72:75]
  v_mfma_f32_16x16x32_bf16 v[76:79], v[24:27], v[108:111], v[76:79]
  v_mfma_f32_16x16x32_bf16 v[80:83], v[24:27], v[112:115], v[80:83]
  v_perm_b32 v84, v196, v192, s48
  v_perm_b32 v88, v196, v192, s49
  v_perm_b32 v85, v204, v200, s48
  v_perm_b32 v89, v204, v200, s49
  v_perm_b32 v86, v212, v208, s48
  v_perm_b32 v90, v212, v208, s49
  v_perm_b32 v87, v220, v216, s48
  v_perm_b32 v91, v220, v216, s49
  v_perm_b32 v92, v197, v193, s48
  v_perm_b32 v96, v197, v193, s49
  v_perm_b32 v93, v205, v201, s48
  v_perm_b32 v97, v205, v201, s49
  v_perm_b32 v94, v213, v209, s48
  v_perm_b32 v98, v213, v209, s49
  v_perm_b32 v95, v221, v217, s48
  v_perm_b32 v99, v221, v217, s49
  v_perm_b32 v100, v198, v194, s48
  v_perm_b32 v104, v198, v194, s49
  v_perm_b32 v101, v206, v202, s48
  v_perm_b32 v105, v206, v202, s49
  v_perm_b32 v102, v214, v210, s48
  v_perm_b32 v106, v214, v210, s49
  v_perm_b32 v103, v222, v218, s48
  v_perm_b32 v107, v222, v218, s49
  v_perm_b32 v108, v199, v195, s48
  v_perm_b32 v112, v199, v195, s49
  v_perm_b32 v109, v207, v203, s48
  v_perm_b32 v113, v207, v203, s49
  v_perm_b32 v110, v215, v211, s48
  v_perm_b32 v114, v215, v211, s49
  v_perm_b32 v111, v223, v219, s48
  v_perm_b32 v115, v223, v219, s49
  s_nop 1
  v_mfma_f32_16x16x32_bf16 v[52:55], v[28:31], v[84:87], v[52:55]
  v_mfma_f32_16x16x32_bf16 v[56:59], v[28:31], v[88:91], v[56:59]
  v_mfma_f32_16x16x32_bf16 v[60:63], v[28:31], v[92:95], v[60:63]
  v_mfma_f32_16x16x32_bf16 v[64:67], v[28:31], v[96:99], v[64:67]
  v_mfma_f32_16x16x32_bf16 v[68:71], v[28:31], v[100:103], v[68:71]
  v_mfma_f32_16x16x32_bf16 v[72:75], v[28:31], v[104:107], v[72:75]
  v_mfma_f32_16x16x32_bf16 v[76:79], v[28:31], v[108:111], v[76:79]
  v_mfma_f32_16x16x32_bf16 v[80:83], v[28:31], v[112:115], v[80:83]
  v_perm_b32 v84, v228, v224, s48
  v_perm_b32 v88, v228, v224, s49
  v_perm_b32 v85, v236, v232, s48
  v_perm_b32 v89, v236, v232, s49
  v_perm_b32 v86, v244, v240, s48
  v_perm_b32 v90, v244, v240, s49
  v_perm_b32 v87, v252, v248, s48
  v_perm_b32 v91, v252, v248, s49
  v_perm_b32 v92, v229, v225, s48
  v_perm_b32 v96, v229, v225, s49
  v_perm_b32 v93, v237, v233, s48
  v_perm_b32 v97, v237, v233, s49
  v_perm_b32 v94, v245, v241, s48
  v_perm_b32 v98, v245, v241, s49
  v_perm_b32 v95, v253, v249, s48
  v_perm_b32 v99, v253, v249, s49
  v_perm_b32 v100, v230, v226, s48
  v_perm_b32 v104, v230, v226, s49
  v_perm_b32 v101, v238, v234, s48
  v_perm_b32 v105, v238, v234, s49
  v_perm_b32 v102, v246, v242, s48
  v_perm_b32 v106, v246, v242, s49
  v_perm_b32 v103, v254, v250, s48
  v_perm_b32 v107, v254, v250, s49
  v_perm_b32 v108, v231, v227, s48
  v_perm_b32 v112, v231, v227, s49
  v_perm_b32 v109, v239, v235, s48
  v_perm_b32 v113, v239, v235, s49
  v_perm_b32 v110, v247, v243, s48
  v_perm_b32 v114, v247, v243, s49
  v_perm_b32 v111, v255, v251, s48
  v_perm_b32 v115, v255, v251, s49
  s_nop 1
  v_mfma_f32_16x16x32_bf16 v[52:55], v[32:35], v[84:87], v[52:55]
  v_mfma_f32_16x16x32_bf16 v[56:59], v[32:35], v[88:91], v[56:59]
  v_mfma_f32_16x16x32_bf16 v[60:63], v[32:35], v[92:95], v[60:63]
  v_mfma_f32_16x16x32_bf16 v[64:67], v[32:35], v[96:99], v[64:67]
  v_mfma_f32_16x16x32_bf16 v[68:71], v[32:35], v[100:103], v[68:71]
  v_mfma_f32_16x16x32_bf16 v[72:75], v[32:35], v[104:107], v[72:75]
  v_mfma_f32_16x16x32_bf16 v[76:79], v[32:35], v[108:111], v[76:79]
  v_mfma_f32_16x16x32_bf16 v[80:83], v[32:35], v[112:115], v[80:83]
  s_add_u32 s68, s68, 1
  s_xor_b32 s69, s68, 0xa5c3965a
  s_nop 2
  v_mov_b32 v128, v52
  v_mov_b32 v129, v56
  v_mov_b32 v130, v60
  v_mov_b32 v131, v64
  s_nop 0
  v_permlane16_swap_b32 v128, v68
  v_permlane16_swap_b32 v129, v72
  v_permlane16_swap_b32 v130, v76
  v_permlane16_swap_b32 v131, v80
  v_permlane16_swap_b32 v53, v69
  v_permlane16_swap_b32 v57, v73
  v_permlane16_swap_b32 v61, v77
  v_permlane16_swap_b32 v65, v81
  s_nop 0
  v_permlane32_swap_b32 v128, v53
  v_permlane32_swap_b32 v129, v57
  v_permlane32_swap_b32 v130, v61
  v_permlane32_swap_b32 v131, v65
  s_nop 0
  ds_write_b128 v4, v[128:131]
  v_mov_b32 v138, s68
  v_mov_b32 v139, s69
  v_mov_b32 v142, s68
  v_mov_b32 v143, s69
  s_waitcnt lgkmcnt(0)
  ds_read_b64 v[136:137], v5 offset:0
  ds_read_b64 v[140:141], v5 offset:512
  s_waitcnt lgkmcnt(0)
  buffer_store_dwordx4 v[136:139], v6, s[32:35], s64 offen offset:0 sc1
  buffer_store_dwordx4 v[140:143], v6, s[32:35], s64 offen offset:1024 sc1
  v_mov_b32 v8, -1
  v_mov_b32 v9, -1
  v_mov_b32 v10, -1
  v_mov_b32 v11, -1
  s_mov_b32 exec_hi, 0xff
  s_add_u32 s52, s66, 0
  buffer_store_dwordx4 v[8:11], v6, s[32:35], s52 offen sc1
  s_add_u32 s52, s66, 40960
  buffer_store_dwordx4 v[8:11], v6, s[32:35], s52 offen sc1
  s_add_u32 s52, s66, 81920
  buffer_store_dwordx4 v[8:11], v6, s[32:35], s52 offen sc1
  s_add_u32 s52, s66, 122880
  buffer_store_dwordx4 v[8:11], v6, s[32:35], s52 offen sc1
  s_add_u32 s52, s66, 163840
  buffer_store_dwordx4 v[8:11], v6, s[32:35], s52 offen sc1
  s_add_u32 s52, s66, 204800
  buffer_store_dwordx4 v[8:11], v6, s[32:35], s52 offen sc1
  s_add_u32 s52, s66, 245760
  buffer_store_dwordx4 v[8:11], v6, s[32:35], s52 offen sc1
  s_add_u32 s52, s66, 286720
  buffer_store_dwordx4 v[8:11], v6, s[32:35], s52 offen sc1
  s_mov_b64 exec, -1
  s_add_u32 s52, s67, 0
  buffer_store_dwordx4 v[8:11], v6, s[32:35], s52 offen offset:0 sc1
  buffer_store_dwordx4 v[8:11], v6, s[32:35], s52 offen offset:1024 sc1
  s_add_u32 s52, s67, 4096
  buffer_store_dwordx4 v[8:11], v6, s[32:35], s52 offen offset:0 sc1
  buffer_store_dwordx4 v[8:11], v6, s[32:35], s52 offen offset:1024 sc1
  s_mov_b64 s[72:73], -1
  s_mov_b64 s[74:75], -1
  s_mov_b32 s61, 0x8000
L_q1:
  s_mov_b64 exec, s[72:73]
  buffer_load_dwordx4 v[128:131], v7, s[32:35], s65 offen offset:0 sc1
  s_mov_b64 exec, s[74:75]
  buffer_load_dwordx4 v[132:135], v7, s[32:35], s65 offen offset:1024 sc1
  s_mov_b64 exec, -1
  s_mov_b64 vcc, 0
  s_waitcnt vmcnt(1)
  v_xor_b32 v3, s68, v130
  v_xor_b32 v16, s69, v131
  v_or_b32 v3, v3, v16
  v_cmp_ne_u32 s[72:73], 0, v3
  s_or_b64 vcc, vcc, s[72:73]
  s_waitcnt vmcnt(0)
  v_xor_b32 v3, s68, v134
  v_xor_b32 v16, s69, v135
  v_or_b32 v3, v3, v16
  v_cmp_ne_u32 s[74:75], 0, v3
  s_or_b64 vcc, vcc, s[74:75]
  s_sub_u32 s61, s61, 1
  s_cbranch_scc1 L_q1_done
  s_cbranch_vccz L_q1_done
  s_sleep 4
  s_branch L_q1
L_q1_done:
  s_nop 1
  v_add_f32_dpp v128, v128, v128 row_ror:8 row_mask:0xf bank_mask:0xf
  v_add_f32_dpp v129, v129, v129 row_ror:8 row_mask:0xf bank_mask:0xf
  v_add_f32_dpp v132, v132, v132 row_ror:8 row_mask:0xf bank_mask:0xf
  v_add_f32_dpp v133, v133, v133 row_ror:8 row_mask:0xf bank_mask:0xf
  v_mov_b32 v84, v128
  v_mov_b32 v85, v129
  v_mov_b32 v86, v132
  v_mov_b32 v87, v133
  s_nop 1
  v_permlane16_swap_b32 v128, v84
  v_permlane16_swap_b32 v129, v85
  v_permlane16_swap_b32 v132, v86
  v_permlane16_swap_b32 v133, v87
  s_nop 1
  v_add_f32 v128, v128, v84
  v_add_f32 v129, v129, v85
  v_add_f32 v132, v132, v86
  v_add_f32 v133, v133, v87
  v_mov_b32 v84, v128
  v_mov_b32 v85, v129
  v_mov_b32 v86, v132
  v_mov_b32 v87, v133
  s_nop 1
  v_permlane32_swap_b32 v128, v84
  v_permlane32_swap_b32 v129, v85
  v_permlane32_swap_b32 v132, v86
  v_permlane32_swap_b32 v133, v87
  s_nop 1
  v_add_f32 v128, v128, v84
  v_add_f32 v129, v129, v85
  v_add_f32 v132, v132, v86
  v_add_f32 v133, v133, v87
  v_cvt_pk_bf16_f32 v136, v128, v129
  v_cvt_pk_bf16_f32 v137, v132, v133
  s_mov_b64 exec, 0xff
  buffer_store_dwordx4 v[136:139], v6, s[32:35], s54 offen sc1
  s_mov_b64 exec, -1
  s_lshl_b32 s65, s56, 13
  s_add_u32 s65, s65, 524288
  s_add_u32 s54, s65, 4096
  v_lshlrev_b32 v4, 2, v0
  v_add_u32 v4, 131072, v4
  s_cmp_eq_u32 s55, 0
  s_cselect_b64 s[90:91], -1, 0
  s_mov_b64 s[72:73], -1
  s_mov_b64 s[74:75], -1
  s_mov_b64 s[76:77], -1
  s_mov_b64 s[78:79], -1
  s_mov_b64 s[80:81], -1
  s_mov_b64 s[82:83], -1
  s_mov_b64 s[84:85], -1
  s_mov_b64 s[86:87], -1
  s_mov_b32 s61, 0x8000
L_q2:
  s_mov_b64 exec, s[72:73]
  buffer_load_dwordx4 v[144:147], v6, s[32:35], s65 offen offset:0 sc1
  s_mov_b64 exec, s[74:75]
  buffer_load_dwordx4 v[148:151], v6, s[32:35], s65 offen offset:1024 sc1
  s_mov_b64 exec, s[76:77]
  buffer_load_dwordx4 v[152:155], v6, s[32:35], s65 offen offset:2048 sc1
  s_mov_b64 exec, s[78:79]
  buffer_load_dwordx4 v[156:159], v6, s[32:35], s65 offen offset:3072 sc1
  s_mov_b64 exec, s[80:81]
  buffer_load_dwordx4 v[160:163], v6, s[32:35], s54 offen offset:0 sc1
  s_mov_b64 exec, s[82:83]
  buffer_load_dwordx4 v[164:167], v6, s[32:35], s54 offen offset:1024 sc1
  s_mov_b64 exec, s[84:85]
  buffer_load_dwordx4 v[168:171], v6, s[32:35], s54 offen offset:2048 sc1
  s_mov_b64 exec, s[86:87]
  buffer_load_dwordx4 v[172:175], v6, s[32:35], s54 offen offset:3072 sc1
  s_mov_b64 exec, -1
  s_mov_b64 vcc, 0
  s_waitcnt vmcnt(7)
  v_xor_b32 v3, s68, v146
  v_xor_b32 v16, s69, v147
  v_or_b32 v3, v3, v16
  v_cmp_ne_u32 s[72:73], 0, v3
  s_or_b64 vcc, vcc, s[72:73]
  s_waitcnt vmcnt(6)
  v_xor_b32 v3, s68, v150
  v_xor_b32 v16, s69, v151
  v_or_b32 v3, v3, v16
  v_cmp_ne_u32 s[74:75], 0, v3
  s_or_b64 vcc, vcc, s[74:75]
  s_waitcnt vmcnt(5)
  v_xor_b32 v3, s68, v154
  v_xor_b32 v16, s69, v155
  v_or_b32 v3, v3, v16
  v_cmp_ne_u32 s[76:77], 0, v3
  s_or_b64 vcc, vcc, s[76:77]
  s_waitcnt vmcnt(4)
  v_xor_b32 v3, s68, v158
  v_xor_b32 v16, s69, v159
  v_or_b32 v3, v3, v16
  v_cmp_ne_u32 s[78:79], 0, v3
  s_or_b64 vcc, vcc, s[78:79]
  s_waitcnt vmcnt(3)
  v_xor_b32 v3, s68, v162
  v_xor_b32 v16, s69, v163
  v_or_b32 v3, v3, v16
  v_cmp_ne_u32 s[80:81], 0, v3
  s_or_b64 vcc, vcc, s[80:81]
  s_waitcnt vmcnt(2)
  v_xor_b32 v3, s68, v166
  v_xor_b32 v16, s69, v167
  v_or_b32 v3, v3, v16
  v_cmp_ne_u32 s[82:83], 0, v3
  s_or_b64 vcc, vcc, s[82:83]
  s_waitcnt vmcnt(1)
  v_xor_b32 v3, s68, v170
  v_xor_b32 v16, s69, v171
  v_or_b32 v3, v3, v16
  v_cmp_ne_u32 s[84:85], 0, v3
  s_or_b64 vcc, vcc, s[84:85]
  s_waitcnt vmcnt(0)
  v_xor_b32 v3, s68, v174
  v_xor_b32 v16, s69, v175
  v_or_b32 v3, v3, v16
  v_cmp_ne_u32 s[86:87], 0, v3
  s_or_b64 vcc, vcc, s[86:87]
  s_sub_u32 s61, s61, 1
  s_cbranch_scc1 L_q2_done
  s_cbranch_vccz L_q2_done
  s_sleep 4
  s_branch L_q2
L_q2_done:
  v_cndmask_b32 v144, v145, v144, s[90:91]
  v_cndmask_b32 v148, v149, v148, s[90:91]
  v_cndmask_b32 v152, v153, v152, s[90:91]
  v_cndmask_b32 v156, v157, v156, s[90:91]
  v_cndmask_b32 v160, v161, v160, s[90:91]
  v_cndmask_b32 v164, v165, v164, s[90:91]
  v_cndmask_b32 v168, v169, v168, s[90:91]
  v_cndmask_b32 v172, v173, v172, s[90:91]
  ds_write_b32 v4, v144 offset:0
  ds_write_b32 v4, v148 offset:256
  ds_write_b32 v4, v152 offset:512
  ds_write_b32 v4, v156 offset:768
  ds_write_b32 v4, v160 offset:1024
  ds_write_b32 v4, v164 offset:1280
  ds_write_b32 v4, v168 offset:1536
  ds_write_b32 v4, v172 offset:1792
  s_waitcnt lgkmcnt(0)
  s_barrier
  v_mov_b32 v17, 1
  s_and_b32 s52, s2, 15
  s_lshl_b32 s52, s52, 4
  v_mov_b32 v18, s52
  s_waitcnt vmcnt(0)
  s_mov_b64 exec, 1
  buffer_atomic_add v17, v18, s[44:47], 0 offen sc1
  s_mov_b64 exec, -1
  v_lshlrev_b32 v4, 4, v0
  s_mov_b32 s61, 0x8000
  s_mov_b64 exec, 0xffff
  s_sleep 64
L_poll1b:
  buffer_load_dword v3, v4, s[44:47], 0 offen sc1
  s_waitcnt vmcnt(0)
  v_cmp_gt_u32 vcc, 16, v3
  s_sub_u32 s61, s61, 1
  s_cbranch_scc1 L_poll1b_done
  s_cbranch_vccz L_poll1b_done
  s_sleep 64
  s_branch L_poll1b
L_poll1b_done:
  s_mov_b64 exec, -1
  v_lshrrev_b32 v3, 3, v0
  v_mul_u32_u24 v6, 5120, v3
  v_and_b32 v3, 7, v0
  v_lshl_add_u32 v4, v3, 4, v6
  v_add_u32 v5, 2560, v4
  v_add_u32 v7, 2560, v6
  s_mul_i32 s64, s58, 40960
  s_add_u32 s64, s64, 1048576
  s_add_u32 s54, s64, 512
  s_lshl_b32 s65, s59, 7
  s_add_u32 s64, s64, s65
  s_mov_b32 s61, 0x8000
  v_mul_u32_u24 v19, 640, v0
  v_lshrrev_b32 v3, 5, v0
  v_lshlrev_b32 v3, 6, v3
  v_and_b32 v16, 7, v0
  v_lshl_add_u32 v16, v16, 3, v3
  v_add_u32 v16, 133376, v16
  s_barrier
  s_mov_b64 s[72:73], -1
  s_mov_b64 s[74:75], -1
  s_mov_b64 s[76:77], -1
  s_mov_b64 s[78:79], -1
  s_mov_b64 s[80:81], -1
  s_mov_b64 s[82:83], -1
  s_mov_b64 s[84:85], -1
  s_mov_b64 s[86:87], -1
L_poll2:
  s_mov_b64 exec, s[72:73]
  buffer_load_dwordx2 v[160:161], v6, s[32:35], s54 offen offset:0 sc1
  buffer_load_dwordx4 v[128:131], v4, s[32:35], s64 offen offset:0 sc1
  s_mov_b64 exec, s[74:75]
  buffer_load_dwordx2 v[162:163], v6, s[32:35], s54 offen offset:640 sc1
  buffer_load_dwordx4 v[132:135], v4, s[32:35], s64 offen offset:640 sc1
  s_mov_b64 exec, s[76:77]
  buffer_load_dwordx2 v[164:165], v6, s[32:35], s54 offen offset:1280 sc1
  buffer_load_dwordx4 v[136:139], v4, s[32:35], s64 offen offset:1280 sc1
  s_mov_b64 exec, s[78:79]
  buffer_load_dwordx2 v[166:167], v6, s[32:35], s54 offen offset:1920 sc1
  buffer_load_dwordx4 v[140:143], v4, s[32:35], s64 offen offset:1920 sc1
  s_mov_b64 exec, s[80:81]
  buffer_load_dwordx2 v[168:169], v7, s[32:35], s54 offen offset:0 sc1
  buffer_load_dwordx4 v[144:147], v5, s[32:35], s64 offen offset:0 sc1
  s_mov_b64 exec, s[82:83]
  buffer_load_dwordx2 v[170:171], v7, s[32:35], s54 offen offset:640 sc1
  buffer_load_dwordx4 v[148:151], v5, s[32:35], s64 offen offset:640 sc1
  s_mov_b64 exec, s[84:85]
  buffer_load_dwordx2 v[172:173], v7, s[32:35], s54 offen offset:1280 sc1
  buffer_load_dwordx4 v[152:155], v5, s[32:35], s64 offen offset:1280 sc1
  s_mov_b64 exec, s[86:87]
  buffer_load_dwordx2 v[174:175], v7, s[32:35], s54 offen offset:1920 sc1
  buffer_load_dwordx4 v[156:159], v5, s[32:35], s64 offen offset:1920 sc1
  s_mov_b64 exec, -1
  s_mov_b64 vcc, 0
  s_waitcnt vmcnt(14)
  v_max3_u32 v3, v128, v129, v130
  v_max3_u32 v3, v3, v131, v160
  v_max_u32 v3, v3, v161
  v_cmp_eq_u32 s[72:73], -1, v3
  s_or_b64 vcc, vcc, s[72:73]
  s_waitcnt vmcnt(12)
  v_max3_u32 v3, v132, v133, v134
  v_max3_u32 v3, v3, v135, v162
  v_max_u32 v3, v3, v163
  v_cmp_eq_u32 s[74:75], -1, v3
  s_or_b64 vcc, vcc, s[74:75]
  s_waitcnt vmcnt(10)
  v_max3_u32 v3, v136, v137, v138
  v_max3_u32 v3, v3, v139, v164
  v_max_u32 v3, v3, v165
  v_cmp_eq_u32 s[76:77], -1, v3
  s_or_b64 vcc, vcc, s[76:77]
  s_waitcnt vmcnt(8)
  v_max3_u32 v3, v140, v141, v142
  v_max3_u32 v3, v3, v143, v166
  v_max_u32 v3, v3, v167
  v_cmp_eq_u32 s[78:79], -1, v3
  s_or_b64 vcc, vcc, s[78:79]
  s_waitcnt vmcnt(6)
  v_max3_u32 v3, v144, v145, v146
  v_max3_u32 v3, v3, v147, v168
  v_max_u32 v3, v3, v169
  v_cmp_eq_u32 s[80:81], -1, v3
  s_or_b64 vcc, vcc, s[80:81]
  s_waitcnt vmcnt(4)
  v_max3_u32 v3, v148, v149, v150
  v_max3_u32 v3, v3, v151, v170
  v_max_u32 v3, v3, v171
  v_cmp_eq_u32 s[82:83], -1, v3
  s_or_b64 vcc, vcc, s[82:83]
  s_waitcnt vmcnt(2)
  v_max3_u32 v3, v152, v153, v154
  v_max3_u32 v3, v3, v155, v172
  v_max_u32 v3, v3, v173
  v_cmp_eq_u32 s[84:85], -1, v3
  s_or_b64 vcc, vcc, s[84:85]
  s_waitcnt vmcnt(0)
  v_max3_u32 v3, v156, v157, v158
  v_max3_u32 v3, v3, v159, v174
  v_max_u32 v3, v3, v175
  v_cmp_eq_u32 s[86:87], -1, v3
  s_or_b64 vcc, vcc, s[86:87]
  s_sub_u32 s61, s61, 1
  s_cbranch_scc1 L_poll2_done
  s_cbranch_vccz L_poll2_done
  s_sleep 2
  s_branch L_poll2
L_poll2_done:
  s_mov_b64 exec, -1
  v_max3_f32 v12, v160, v162, v164
  v_max3_f32 v12, v12, v166, v168
  v_max3_f32 v12, v12, v170, v172
  v_max_f32 v12, v12, v174
  s_nop 1
  v_max_f32_dpp v12, v12, v12 row_ror:8 row_mask:0xf bank_mask:0xf
  v_mov_b32 v84, v12
  s_nop 1
  v_permlane16_swap_b32 v12, v84
  s_nop 1
  v_max_f32 v12, v12, v84
  v_sub_f32 v160, v160, v12
  v_sub_f32 v162, v162, v12
  v_sub_f32 v164, v164, v12
  v_sub_f32 v166, v166, v12
  v_sub_f32 v168, v168, v12
  v_sub_f32 v170, v170, v12
  v_sub_f32 v172, v172, v12
  v_sub_f32 v174, v174, v12
  v_exp_f32 v160, v160
  v_exp_f32 v162, v162
  v_exp_f32 v164, v164
  v_exp_f32 v166, v166
  v_exp_f32 v168, v168
  v_exp_f32 v170, v170
  v_exp_f32 v172, v172
  v_exp_f32 v174, v174
  s_nop 0
  v_mul_f32 v13, v160, v161
  v_fmac_f32 v13, v162, v163
  v_fmac_f32 v13, v164, v165
  v_fmac_f32 v13, v166, v167
  v_fmac_f32 v13, v168, v169
  v_fmac_f32 v13, v170, v171
  v_fmac_f32 v13, v172, v173
  v_fmac_f32 v13, v174, v175
  v_mul_f32 v128, v160, v128
  v_mul_f32 v129, v160, v129
  v_mul_f32 v130, v160, v130
  v_mul_f32 v131, v160, v131
  v_fmac_f32 v128, v162, v132
  v_fmac_f32 v129, v162, v133
  v_fmac_f32 v130, v162, v134
  v_fmac_f32 v131, v162, v135
  v_fmac_f32 v128, v164, v136
  v_fmac_f32 v129, v164, v137
  v_fmac_f32 v130, v164, v138
  v_fmac_f32 v131, v164, v139
  v_fmac_f32 v128, v166, v140
  v_fmac_f32 v129, v166, v141
  v_fmac_f32 v130, v166, v142
  v_fmac_f32 v131, v166, v143
  v_fmac_f32 v128, v168, v144
  v_fmac_f32 v129, v168, v145
  v_fmac_f32 v130, v168, v146
  v_fmac_f32 v131, v168, v147
  v_fmac_f32 v128, v170, v148
  v_fmac_f32 v129, v170, v149
  v_fmac_f32 v130, v170, v150
  v_fmac_f32 v131, v170, v151
  v_fmac_f32 v128, v172, v152
  v_fmac_f32 v129, v172, v153
  v_fmac_f32 v130, v172, v154
  v_fmac_f32 v131, v172, v155
  v_fmac_f32 v128, v174, v156
  v_fmac_f32 v129, v174, v157
  v_fmac_f32 v130, v174, v158
  v_fmac_f32 v131, v174, v159
  s_nop 1
  v_add_f32_dpp v13, v13, v13 row_ror:8 row_mask:0xf bank_mask:0xf
  v_add_f32_dpp v128, v128, v128 row_ror:8 row_mask:0xf bank_mask:0xf
  v_add_f32_dpp v129, v129, v129 row_ror:8 row_mask:0xf bank_mask:0xf
  v_add_f32_dpp v130, v130, v130 row_ror:8 row_mask:0xf bank_mask:0xf
  v_add_f32_dpp v131, v131, v131 row_ror:8 row_mask:0xf bank_mask:0xf
  v_mov_b32 v84, v13
  v_mov_b32 v85, v128
  v_mov_b32 v86, v129
  v_mov_b32 v87, v130
  v_mov_b32 v88, v131
  s_nop 1
  v_permlane16_swap_b32 v13, v84
  v_permlane16_swap_b32 v128, v85
  v_permlane16_swap_b32 v129, v86
  v_permlane16_swap_b32 v130, v87
  v_permlane16_swap_b32 v131, v88
  s_nop 1
  v_add_f32 v13, v13, v84
  v_add_f32 v128, v128, v85
  v_add_f32 v129, v129, v86
  v_add_f32 v130, v130, v87
  v_add_f32 v131, v131, v88
  v_rcp_f32 v13, v13
  s_nop 0
  v_mul_f32 v128, v128, v13
  v_mul_f32 v129, v129, v13
  v_mul_f32 v130, v130, v13
  v_mul_f32 v131, v131, v13
  v_cvt_pk_bf16_f32 v128, v128, v129
  v_cvt_pk_bf16_f32 v129, v130, v131
  s_mov_b32 exec_lo, 0xff
  s_mov_b32 exec_hi, 0xff
  ds_write_b64 v16, v[128:129]
  s_mov_b64 exec, -1
  s_waitcnt lgkmcnt(0)
  s_barrier
  s_cmp_lg_u32 s56, 0
  s_cbranch_scc1 L_done
  v_lshrrev_b32 v3, 3, v0
  v_mul_u32_u24 v4, 8320, v3
  v_and_b32 v3, 7, v0
  v_lshl_add_u32 v4, v3, 4, v4
  v_lshlrev_b32 v5, 3, v3
  s_lshr_b32 s64, s2, 7
  s_lshl_b32 s64, s64, 12
  s_bfe_u32 s65, s2, 0x50002
  s_lshl_b32 s65, s65, 7
  s_add_u32 s64, s64, s65
  s_lshr_b32 s65, s64, 1
  s_add_u32 s64, s64, 3145728
  s_mov_b32 s61, 0x8000
  s_mov_b64 s[72:73], -1
  s_mov_b64 s[74:75], -1
  s_mov_b64 s[76:77], -1
  s_mov_b64 s[78:79], -1
  s_mov_b64 s[80:81], -1
  s_mov_b64 s[82:83], -1
  s_mov_b64 s[84:85], -1
  s_mov_b64 s[86:87], -1
L_poll3:
  s_mov_b64 exec, s[72:73]
  s_add_u32 s52, s64, 0
  buffer_load_dwordx4 v[128:131], v4, s[32:35], s52 offen sc1
  s_add_u32 s52, s64, 66560
  buffer_load_dwordx4 v[132:135], v4, s[32:35], s52 offen sc1
  s_mov_b64 exec, s[74:75]
  s_add_u32 s52, s64, 133120
  buffer_load_dwordx4 v[136:139], v4, s[32:35], s52 offen sc1
  s_add_u32 s52, s64, 199680
  buffer_load_dwordx4 v[140:143], v4, s[32:35], s52 offen sc1
  s_mov_b64 exec, s[76:77]
  s_add_u32 s52, s64, 266240
  buffer_load_dwordx4 v[144:147], v4, s[32:35], s52 offen sc1
  s_add_u32 s52, s64, 332800
  buffer_load_dwordx4 v[148:151], v4, s[32:35], s52 offen sc1
  s_mov_b64 exec, s[78:79]
  s_add_u32 s52, s64, 399360
  buffer_load_dwordx4 v[152:155], v4, s[32:35], s52 offen sc1
  s_add_u32 s52, s64, 465920
  buffer_load_dwordx4 v[156:159], v4, s[32:35], s52 offen sc1
  s_mov_b64 exec, s[80:81]
  s_add_u32 s52, s64, 532480
  buffer_load_dwordx4 v[160:163], v4, s[32:35], s52 offen sc1
  s_add_u32 s52, s64, 599040
  buffer_load_dwordx4 v[164:167], v4, s[32:35], s52 offen sc1
  s_mov_b64 exec, s[82:83]
  s_add_u32 s52, s64, 665600
  buffer_load_dwordx4 v[168:171], v4, s[32:35], s52 offen sc1
  s_add_u32 s52, s64, 732160
  buffer_load_dwordx4 v[172:175], v4, s[32:35], s52 offen sc1
  s_mov_b64 exec, s[84:85]
  s_add_u32 s52, s64, 798720
  buffer_load_dwordx4 v[176:179], v4, s[32:35], s52 offen sc1
  s_add_u32 s52, s64, 865280
  buffer_load_dwordx4 v[180:183], v4, s[32:35], s52 offen sc1
  s_mov_b64 exec, s[86:87]
  s_add_u32 s52, s64, 931840
  buffer_load_dwordx4 v[184:187], v4, s[32:35], s52 offen sc1
  s_add_u32 s52, s64, 998400
  buffer_load_dwordx4 v[188:191], v4, s[32:35], s52 offen sc1
  s_mov_b64 exec, -1
  s_mov_b64 vcc, 0
  s_waitcnt vmcnt(14)
  v_max3_u32 v3, v128, v129, v130
  v_max3_u32 v3, v3, v131, v132
  v_max3_u32 v3, v3, v133, v134
  v_max_u32 v3, v3, v135
  v_cmp_eq_u32 s[72:73], -1, v3
  s_or_b64 vcc, vcc, s[72:73]
  s_waitcnt vmcnt(12)
  v_max3_u32 v3, v136, v137, v138
  v_max3_u32 v3, v3, v139, v140
  v_max3_u32 v3, v3, v141, v142
  v_max_u32 v3, v3, v143
  v_cmp_eq_u32 s[74:75], -1, v3
  s_or_b64 vcc, vcc, s[74:75]
  s_waitcnt vmcnt(10)
  v_max3_u32 v3, v144, v145, v146
  v_max3_u32 v3, v3, v147, v148
  v_max3_u32 v3, v3, v149, v150
  v_max_u32 v3, v3, v151
  v_cmp_eq_u32 s[76:77], -1, v3
  s_or_b64 vcc, vcc, s[76:77]
  s_waitcnt vmcnt(8)
  v_max3_u32 v3, v152, v153, v154
  v_max3_u32 v3, v3, v155, v156
  v_max3_u32 v3, v3, v157, v158
  v_max_u32 v3, v3, v159
  v_cmp_eq_u32 s[78:79], -1, v3
  s_or_b64 vcc, vcc, s[78:79]
  s_waitcnt vmcnt(6)
  v_max3_u32 v3, v160, v161, v162
  v_max3_u32 v3, v3, v163, v164
  v_max3_u32 v3, v3, v165, v166
  v_max_u32 v3, v3, v167
  v_cmp_eq_u32 s[80:81], -1, v3
  s_or_b64 vcc, vcc, s[80:81]
  s_waitcnt vmcnt(4)
  v_max3_u32 v3, v168, v169, v170
  v_max3_u32 v3, v3, v171, v172
  v_max3_u32 v3, v3, v173, v174
  v_max_u32 v3, v3, v175
  v_cmp_eq_u32 s[82:83], -1, v3
  s_or_b64 vcc, vcc, s[82:83]
  s_waitcnt vmcnt(2)
  v_max3_u32 v3, v176, v177, v178
  v_max3_u32 v3, v3, v179, v180
  v_max3_u32 v3, v3, v181, v182
  v_max_u32 v3, v3, v183
  v_cmp_eq_u32 s[84:85], -1, v3
  s_or_b64 vcc, vcc, s[84:85]
  s_waitcnt vmcnt(0)
  v_max3_u32 v3, v184, v185, v186
  v_max3_u32 v3, v3, v187, v188
  v_max3_u32 v3, v3, v189, v190
  v_max_u32 v3, v3, v191
  v_cmp_eq_u32 s[86:87], -1, v3
  s_or_b64 vcc, vcc, s[86:87]
  s_sub_u32 s61, s61, 1
  s_cbranch_scc1 L_poll3_done
  s_cbranch_vccz L_poll3_done
  s_branch L_poll3
L_poll3_done:
  s_mov_b64 exec, -1
  v_add_f32 v128, v128, v160
  v_add_f32 v129, v129, v161
  v_add_f32 v130, v130, v162
  v_add_f32 v131, v131, v163
  v_add_f32 v132, v132, v164
  v_add_f32 v133, v133, v165
  v_add_f32 v134, v134, v166
  v_add_f32 v135, v135, v167
  v_add_f32 v136, v136, v168
  v_add_f32 v137, v137, v169
  v_add_f32 v138, v138, v170
  v_add_f32 v139, v139, v171
  v_add_f32 v140, v140, v172
  v_add_f32 v141, v141, v173
  v_add_f32 v142, v142, v174
  v_add_f32 v143, v143, v175
  v_add_f32 v144, v144, v176
  v_add_f32 v145, v145, v177
  v_add_f32 v146, v146, v178
  v_add_f32 v147, v147, v179
  v_add_f32 v148, v148, v180
  v_add_f32 v149, v149, v181
  v_add_f32 v150, v150, v182
  v_add_f32 v151, v151, v183
  v_add_f32 v152, v152, v184
  v_add_f32 v153, v153, v185
  v_add_f32 v154, v154, v186
  v_add_f32 v155, v155, v187
  v_add_f32 v156, v156, v188
  v_add_f32 v157, v157, v189
  v_add_f32 v158, v158, v190
  v_add_f32 v159, v159, v191
  v_add_f32 v128, v128, v144
  v_add_f32 v129, v129, v145
  v_add_f32 v130, v130, v146
  v_add_f32 v131, v131, v147
  v_add_f32 v132, v132, v148
  v_add_f32 v133, v133, v149
  v_add_f32 v134, v134, v150
  v_add_f32 v135, v135, v151
  v_add_f32 v136, v136, v152
  v_add_f32 v137, v137, v153
  v_add_f32 v138, v138, v154
  v_add_f32 v139, v139, v155
  v_add_f32 v140, v140, v156
  v_add_f32 v141, v141, v157
  v_add_f32 v142, v142, v158
  v_add_f32 v143, v143, v159
  v_add_f32 v128, v128, v136
  v_add_f32 v129, v129, v137
  v_add_f32 v130, v130, v138
  v_add_f32 v131, v131, v139
  v_add_f32 v132, v132, v140
  v_add_f32 v133, v133, v141
  v_add_f32 v134, v134, v142
  v_add_f32 v135, v135, v143
  v_add_f32 v128, v128, v132
  v_add_f32 v129, v129, v133
  v_add_f32 v130, v130, v134
  v_add_f32 v131, v131, v135
  s_nop 0
  v_add_f32_dpp v128, v128, v128 row_ror:8 row_mask:0xf bank_mask:0xf
  v_add_f32_dpp v129, v129, v129 row_ror:8 row_mask:0xf bank_mask:0xf
  v_add_f32_dpp v130, v130, v130 row_ror:8 row_mask:0xf bank_mask:0xf
  v_add_f32_dpp v131, v131, v131 row_ror:8 row_mask:0xf bank_mask:0xf
  v_mov_b32 v132, v128
  v_mov_b32 v133, v129
  v_mov_b32 v134, v130
  v_mov_b32 v135, v131
  s_nop 1
  v_permlane16_swap_b32 v128, v132
  v_permlane16_swap_b32 v129, v133
  v_permlane16_swap_b32 v130, v134
  v_permlane16_swap_b32 v131, v135
  s_nop 1
  v_add_f32 v128, v128, v132
  v_add_f32 v129, v129, v133
  v_add_f32 v130, v130, v134
  v_add_f32 v131, v131, v135
  v_mov_b32 v132, v128
  v_mov_b32 v133, v129
  v_mov_b32 v134, v130
  v_mov_b32 v135, v131
  s_nop 1
  v_permlane32_swap_b32 v128, v132
  v_permlane32_swap_b32 v129, v133
  v_permlane32_swap_b32 v130, v134
  v_permlane32_swap_b32 v131, v135
  s_nop 1
  v_add_f32 v128, v128, v132
  v_add_f32 v129, v129, v133
  v_add_f32 v130, v130, v134
  v_add_f32 v131, v131, v135
  v_cvt_pk_bf16_f32 v128, v128, v129
  v_cvt_pk_bf16_f32 v129, v130, v131
  s_mov_b64 exec, 0xff
  buffer_store_dwordx2 v[128:129], v5, s[40:43], s65 offen
  s_mov_b64 exec, -1
  s_cmp_lg_u32 s2, 0
  s_cbranch_scc1 L_noep
  v_mov_b32 v3, s68
  v_lshlrev_b32 v4, 2, v0
  s_mov_b32 s52, 655360
  s_mov_b32 exec_hi, 0
  buffer_store_dword v3, v4, s[32:35], s52 offen sc1
  s_mov_b64 exec, -1
L_noep:
L_done:
  s_endpgm
.section .rodata,"a"
.p2align 6
.amdhsa_kernel standalone__gqa_block_cached__decode_kernel
  .amdhsa_next_free_vgpr 256
  .amdhsa_next_free_sgpr 96
  .amdhsa_accum_offset 256
  .amdhsa_group_segment_fixed_size 0
  .amdhsa_kernarg_size 64
  .amdhsa_user_sgpr_count 2
  .amdhsa_user_sgpr_kernarg_segment_ptr 1
  .amdhsa_system_sgpr_workgroup_id_x 1
  .amdhsa_float_denorm_mode_32 3
.end_amdhsa_kernel
```
